```python
import torch

def _softmax(x, axis=-1):
    return torch.softmax(x, dim=axis)
def _gelu(x):
    return torch.nn.functional.gelu(x, approximate="tanh")
def _silu(x):
    return torch.nn.functional.silu(x)
def _sigmoid(x):
    return torch.sigmoid(x)
def _layernorm(x, axis=-1, eps=1e-5):
    m = x.mean(dim=axis, keepdim=True)
    v = x.var(dim=axis, keepdim=True, unbiased=False)
    return (x - m) / torch.sqrt(v + eps)
def _scatter_add(tgt, idx, src, axis=0):
    return tgt.clone().index_add_(axis, idx, src)
def _segment_sum(src, seg, n):
    out = torch.zeros((n,) + src.shape[1:], dtype=src.dtype)
    return out.index_add_(0, seg, src)
def _pad(x, pw):
    flat = tuple(v for pair in reversed(pw) for v in pair)
    return torch.nn.functional.pad(x, flat)

kernel_name = 'sequential_preLN__ssm_conv_s4d__dense_activation_relu__prompt'

def setup_inputs():

    _w = (lambda a: (lambda t: t.to(torch.bfloat16) if t.is_floating_point() else t)(torch.as_tensor(a)))
    def _A_setup():
        Bsz, L, D, N = 1, 2048, 512, 128
        return {
            "u": _w((lambda *s: torch.randn(*s, dtype=torch.bfloat16) * 0.05)(Bsz, L, D)),
            "log_A_real": _w((lambda *s: torch.randn(*s, dtype=torch.bfloat16) * 6.4)(D, N) * 0.5),
            "A_imag": _w((lambda *s: torch.randn(*s, dtype=torch.bfloat16) * 0.05)(D, N) * 3.14),
            "C_real": _w((lambda *s: torch.randn(*s, dtype=torch.bfloat16) * 0.05)(D, N) / N ** 0.5),
            "C_imag": _w((lambda *s: torch.randn(*s, dtype=torch.bfloat16) * 0.05)(D, N) / N ** 0.5),
            "log_dt": _w((lambda *s: torch.randn(*s, dtype=torch.bfloat16) * 0.05)(D) * 0.5 - 4.0),
            "D_skip": _w((lambda *s: torch.randn(*s, dtype=torch.bfloat16) * 0.05)(D)),
        }
    _A_in = _A_setup()

    def _B_setup():
        B, S, D, Dff = 1, 2048, 512, 1792
        return {
            "x": _w((lambda *s: torch.randn(*s, dtype=torch.bfloat16) * 0.05)(B, S, D)),
            "w1": _w((lambda *s: torch.randn(*s, dtype=torch.bfloat16) * 0.05)(D, Dff)),
            "w2": _w((lambda *s: torch.randn(*s, dtype=torch.bfloat16) * 0.05)(Dff, D)),
        }
    _B_in = _B_setup()

    return {
        "A_u": _A_in["u"],
        "A_log_A_real": _A_in["log_A_real"],
        "A_A_imag": _A_in["A_imag"],
        "A_C_real": _A_in["C_real"],
        "A_C_imag": _A_in["C_imag"],
        "A_log_dt": _A_in["log_dt"],
        "A_D_skip": _A_in["D_skip"],
        "B_x": _B_in["x"],
        "B_w1": _B_in["w1"],
        "B_w2": _B_in["w2"],
    }

def reference(A_u, A_log_A_real, A_A_imag, A_C_real, A_C_imag, A_log_dt, A_D_skip, B_x, B_w1, B_w2):
    def _A_ref(u, log_A_real, A_imag, C_real, C_imag, log_dt, D_skip):
        L = u.shape[1]
        dt = torch.exp(log_dt)
        A = -torch.exp(log_A_real) + 1j * A_imag
        C = (C_real + 1j * C_imag) * dt[:, None]
        pos = (lambda x, dt: x.to(dt))(torch.arange(L), log_dt.dtype)
        P = torch.exp((A * dt[:, None])[:, :, None] * pos[None, None, :])
        K = 2.0 * torch.einsum("dn,dnl->dl", C, P).real
        L2 = 2 * L
        u_t = (lambda x, *d: x.permute(*d))(u, 0, 2, 1)
        Kf = (lambda x, *a, **k: torch.fft.rfft(x.float(), *a, **k))(K, L2)
        Uf = (lambda x, *a, **k: torch.fft.rfft(x.float(), *a, **k))(u_t, L2)
        y = (lambda x, *a, **k: torch.fft.irfft(x, *a, **k).to(torch.bfloat16))(Uf * Kf[None, :, :], L2)[:, :, :L]
        y = (lambda x, *d: x.permute(*d))(y, 0, 2, 1)
        return y + u * D_skip[None, None, :]

    def _B_ref(x, w1, w2):
        h = torch.einsum("bsd,df->bsf", x, w1)
        zero = torch.zeros_like(h)
        h = torch.maximum(h, zero)
        return torch.einsum("bsf,fd->bsd", h, w2)

    x = A_u
    h = x + _A_ref(_layernorm(x, axis=-1), A_log_A_real, A_A_imag, A_C_real, A_C_imag, A_log_dt, A_D_skip)
    h2 = h + _B_ref(_layernorm(h, axis=-1), B_w1, B_w2)
    return h2
```

```asm
; @launch kernel=kf_kernel grid=(256,1,1) block=(512,1,1) lds=163840
.amdgcn_target "amdgcn-amd-amdhsa--gfx950"
.text
.globl kf_kernel
.p2align 8
.type kf_kernel,@function
kf_kernel:
    s_cmp_ge_u32 s2, 256
    s_cbranch_scc1 kf_kernel_end
    s_load_dwordx16 s[4:19], s[0:1], 0
    s_load_dwordx2 s[28:29], s[0:1], 96
    v_lshrrev_b32 v2, 6, v0
    v_and_b32 v1, 63, v0
    s_load_dwordx4 s[24:27], s[0:1], 64
    v_readfirstlane_b32 s20, v2
    s_lshr_b32 s31, s2, 3
    s_cmp_ge_u32 s20, 4
    s_cbranch_scc0 kf_kernel_t1
    s_setprio 2
    s_and_b32 s34, s20, 3
    v_lshrrev_b32 v17, 4, v1
    v_mul_u32_u24 v42, 0x440, v17
    v_lshlrev_b32 v18, 4, v1
    v_and_b32 v19, 0xf0, v18
    v_xor_b32 v42, v42, v19
    s_lshl_b32 s35, s2, 13
    s_lshl_b32 s37, s34, 8
    s_add_u32 s37, s37, s35
    v_add_u32 v42, s37, v42
    v_add_u32 v43, 4096, v42
    s_lshl_b32 s36, s34, 11
    s_add_u32 s22, s36, 69632
    s_mov_b32 m0, s22
    v_mov_b32 v49, 0x1140000
    s_waitcnt lgkmcnt(0)
    global_load_lds_dwordx4 v42, s[4:5]
    s_add_u32 m0, m0, 1024
    global_load_dword v16, v49, s[28:29] sc1
    global_load_lds_dwordx4 v43, s[4:5]
    s_branch kf_kernel_h2
kf_kernel_t1:
    s_getpc_b64 s[60:61]
kf_kernel_pc:
    s_mul_i32 s62, s31, 1280
    s_min_u32 s62, s62, code_end-kf_kernel_pc-2048
    v_lshl_add_u32 v3, v0, 3, s62
    global_load_dwordx2 v[204:205], v3, s[60:61]
    v_mov_b64 v[4:5], 0
    v_mov_b64 v[6:7], 0
    v_mov_b64 v[8:9], 0
    s_and_b32 s30, s2, 7
    s_lshl_b32 s32, s30, 5
    s_add_u32 s32, s32, s31
    s_lshl_b32 s36, s32, 9
    v_lshl_add_u32 v12, v0, 1, s36
    s_lshr_b32 s33, s20, 1
    s_lshl_b32 s35, s32, 1
    s_add_u32 s35, s35, s33
    s_lshl_b32 s37, s35, 1
    v_xor_b32 v3, 128, v12
    v_mov_b32 v11, s37
    v_mov_b32 v10, 0
    v_mov_b32 v70, 0
    s_waitcnt lgkmcnt(0)
    global_load_short_d16_hi v10, v11, s[14:15]
    global_load_short_d16_hi v4, v12, s[6:7]
    global_load_short_d16_hi v5, v12, s[8:9]
    global_load_short_d16_hi v6, v12, s[10:11]
    global_load_short_d16_hi v7, v12, s[12:13]
    global_load_short_d16_hi v8, v3, s[10:11]
    global_load_short_d16_hi v9, v3, s[12:13]
    global_load_short_d16_hi v70, v11, s[16:17]
    s_branch kf_kernel_t2
kf_kernel_h2:
    v_lshlrev_b32 v15, 2, v2
    v_mov_b32 v25, 0
    v_add_u32 v15, 161280, v15
    ds_write_b32 v15, v25 offset:0
    ds_write_b32 v15, v25 offset:32
    ds_write_b32 v15, v25 offset:64
    s_mov_b32 s64, s28
    s_and_b32 s65, s29, 0xffff
    s_mov_b32 s66, 0x1200000
    s_mov_b32 s67, 0x20000
    v_lshrrev_b32 v2, 5, v1
    v_and_b32 v3, 31, v1
    v_bfe_u32 v18, v1, 2, 2
    v_mul_u32_u24 v44, 320, v18
    v_lshl_add_u32 v44, v2, 10, v44
    v_and_b32 v17, 1, v17
    v_lshl_add_u32 v44, v17, 5, v44
    v_and_b32 v19, 3, v1
    v_lshl_add_u32 v44, v19, 3, v44
    v_add_u32 v44, s22, v44
    v_lshlrev_b32 v48, 5, v3
    v_lshl_add_u32 v48, v2, 4, v48
    v_xor_b32 v45, 64, v44
    v_xor_b32 v46, 128, v44
    v_xor_b32 v47, 192, v44
    s_and_b32 s37, s2, 7
    s_lshl_b32 s37, s37, 7
    v_xor_b32 v48, s37, v48
    s_lshl_b32 s37, s2, 14
    s_lshl_b32 s38, s34, 12
    s_add_u32 s37, s37, s38
    s_add_u32 s19, s37, 0x400000
    v_mov_b64 v[20:21], 0
    v_mov_b64 v[22:23], 0
    v_mov_b32 v24, 0x3f803f80
    v_lshrrev_b32 v18, 3, v1
    v_and_b32 v41, 7, v1
    v_lshlrev_b32 v40, 5, v41
    v_add_u32 v40, 161536, v40
    v_lshlrev_b32 v41, 4, v41
    v_and_b32 v28, 1, v18
    v_lshl_add_u32 v41, v28, 7, v41
    v_lshl_add_u32 v41, v18, 8, v41
    v_add_u32 v41, s22, v41
    s_lshl_b32 s36, s34, 3
    s_add_u32 s36, s36, 161536
    v_lshl_add_u32 v54, v18, 5, s36
    v_xor_b32 v55, 128, v41
    v_lshrrev_b32 v49, 1, v1
    v_lshlrev_b32 v49, 4, v49
    v_mov_b32 v26, 1
    s_mov_b32 s60, 0
    v_mov_b32 v27, 161280
    s_waitcnt lgkmcnt(0)
    s_barrier
    s_waitcnt vmcnt(0)
    ds_read_b64_tr_b16 v[96:97], v44
    ds_read_b64_tr_b16 v[100:101], v45
    ds_read_b64_tr_b16 v[104:105], v46
    ds_read_b64_tr_b16 v[108:109], v47
    ds_read_b128 v[32:35], v41
    ds_read_b128 v[36:39], v55
    v_add_u32 v16, 0x9e3779b9, v16
    v_mov_b32 v98, v16
    v_mov_b32 v99, v16
    v_mov_b32 v102, v16
    v_mov_b32 v103, v16
    v_mov_b32 v106, v16
    v_mov_b32 v107, v16
    v_mov_b32 v110, v16
    v_mov_b32 v111, v16
    s_waitcnt lgkmcnt(5)
    buffer_store_dwordx4 v[96:99], v48, s[64:67], s19 offen offset:0 sc1
    s_waitcnt lgkmcnt(4)
    buffer_store_dwordx4 v[100:103], v48, s[64:67], s19 offen offset:1024 sc1
    s_waitcnt lgkmcnt(3)
    buffer_store_dwordx4 v[104:107], v48, s[64:67], s19 offen offset:2048 sc1
    s_waitcnt lgkmcnt(2)
    buffer_store_dwordx4 v[108:111], v48, s[64:67], s19 offen offset:3072 sc1
    s_waitcnt lgkmcnt(0)
    v_dot2c_f32_bf16 v20, v32, v24
    v_dot2c_f32_bf16 v22, v32, v32
    v_dot2c_f32_bf16 v21, v33, v24
    v_dot2c_f32_bf16 v23, v33, v33
    v_dot2c_f32_bf16 v20, v34, v24
    v_dot2c_f32_bf16 v22, v34, v34
    v_dot2c_f32_bf16 v21, v35, v24
    v_dot2c_f32_bf16 v23, v35, v35
    v_dot2c_f32_bf16 v20, v36, v24
    v_dot2c_f32_bf16 v22, v36, v36
    v_dot2c_f32_bf16 v21, v37, v24
    v_dot2c_f32_bf16 v23, v37, v37
    v_dot2c_f32_bf16 v20, v38, v24
    v_dot2c_f32_bf16 v22, v38, v38
    v_dot2c_f32_bf16 v21, v39, v24
    v_dot2c_f32_bf16 v23, v39, v39
    ds_write_b32 v27, v16 offset:96
    s_lshl_b32 s38, s2, 6
    s_add_u32 s38, s38, 0x1150000
    v_add_f32 v20, v20, v21
    v_add_f32 v21, v22, v23
    s_nop 0
    v_add_f32_dpp v20, v20, v20 quad_perm:[1,0,3,2] row_mask:0xf bank_mask:0xf
    v_add_f32_dpp v21, v21, v21 quad_perm:[1,0,3,2] row_mask:0xf bank_mask:0xf
    s_nop 0
    v_add_f32_dpp v20, v20, v20 quad_perm:[2,3,0,1] row_mask:0xf bank_mask:0xf
    v_add_f32_dpp v21, v21, v21 quad_perm:[2,3,0,1] row_mask:0xf bank_mask:0xf
    s_nop 0
    v_add_f32_dpp v20, v20, v20 row_half_mirror row_mask:0xf bank_mask:0xf
    v_add_f32_dpp v21, v21, v21 row_half_mirror row_mask:0xf bank_mask:0xf
    s_mov_b32 exec_lo, 0x01010101
    s_mov_b32 exec_hi, 0x01010101
    ds_write_b64 v54, v[20:21]
    s_mov_b64 exec, 1
    ds_add_rtn_u32 v28, v27, v26 offset:92
    s_mov_b64 exec, -1
    v_mov_b32 v30, v16
    v_mov_b32 v31, v16
    s_waitcnt lgkmcnt(0)
    v_readfirstlane_b32 s36, v28
    s_cmp_lg_u32 s36, 3
    s_cbranch_scc1 kf_kernel_nst
    ds_read_b128 v[32:35], v40
    ds_read_b128 v[36:39], v40 offset:16
    s_waitcnt lgkmcnt(0)
    v_pk_add_f32 v[32:33], v[32:33], v[34:35]
    v_pk_add_f32 v[36:37], v[36:37], v[38:39]
    v_pk_add_f32 v[32:33], v[32:33], v[36:37]
    v_mul_f32 v32, 0x3b000000, v32
    v_mul_f32 v33, 0x3b000000, v33
    v_fma_f32 v33, -v32, v32, v33
    v_max_f32 v33, 0, v33
    v_cvt_pk_bf16_f32 v33, v33, v33
    v_and_b32 v33, 0xffff0000, v33
    v_add_f32 v33, 0x3727c5ac, v33
    v_cvt_pk_bf16_f32 v33, v33, v33
    v_and_b32 v33, 0xffff0000, v33
    v_sqrt_f32 v33, v33
    s_nop 0
    v_cvt_pk_bf16_f32 v28, v33, v32
    s_nop 1
    v_mov_b32_dpp v29, v28 row_shl:1 row_mask:0xf bank_mask:0xf
    s_mov_b64 exec, 0x55
    buffer_store_dwordx4 v[28:31], v49, s[64:67], s38 offen sc1
    s_mov_b64 exec, -1
kf_kernel_nst:
    s_setprio 0
    s_branch kf_kernel_h3
kf_kernel_t2:
    s_setprio 1
    v_lshlrev_b32 v203, 2, v2
    v_mov_b32 v25, 0
    v_add_u32 v203, 161280, v203
    ds_write_b32 v203, v25 offset:0
    ds_write_b32 v203, v25 offset:32
    ds_write_b32 v203, v25 offset:64
    s_and_b32 s34, s20, 1
    s_mul_i32 s36, s33, 34816
    s_lshl_b32 s37, s34, 8
    s_add_u32 m0, s37, s36
    s_mov_b32 s40, 0x3fb8aa3b
    s_mov_b32 s41, 0x3e22f983
    v_add_u32 v12, s34, v1
    v_cmp_eq_u32 vcc, 0, v12
    v_and_b32 v3, 15, v1
    v_mul_u32_u24 v13, 544, v3
    v_lshrrev_b32 v2, 4, v1
    v_lshl_add_u32 v13, v2, 4, v13
    v_add_u32 v13, s36, v13
    s_mul_i32 s37, s34, 8704
    s_add_u32 s37, s37, 17408
    v_add_u32 v14, s37, v13
    s_mul_i32 s46, s33, 8320
    s_add_u32 s46, s46, 107712
    s_lshl_b32 s37, s34, 8
    s_sub_u32 s37, 2542, s37
    s_add_u32 s37, s37, s46
    v_lshlrev_b32 v12, 4, v3
    v_sub_u32 v15, s37, v12
    v_lshlrev_b32 v12, v2, 1
    v_lshrrev_b32 v12, 1, v12
    v_lshlrev_b32 v12, 9, v12
    v_sub_u32 v15, v15, v12
    s_mov_b32 s64, s28
    s_and_b32 s65, s29, 0xffff
    s_mov_b32 s66, 0x1200000
    s_mov_b32 s67, 0x20000
    s_waitcnt lgkmcnt(0)
    s_barrier
    s_mov_b32 s68, s24
    s_and_b32 s69, s25, 0xffff
    s_mov_b32 s70, 0x1c0000
    s_mov_b32 s71, 0x20000
    s_mov_b32 s72, s26
    s_and_b32 s73, s27, 0xffff
    s_mov_b32 s74, 0x1c0000
    s_mov_b32 s75, 0x20000
    s_mul_i32 s44, s20, 1792
    s_add_u32 s44, s44, 0
    v_lshl_add_u32 v240, v1, 4, s44
    v_and_b32 v244, 0xfffffe00, v240
    v_add_u32 v240, v240, v244
    s_mul_i32 s44, s20, 1792
    s_add_u32 s44, s44, 896
    v_lshl_add_u32 v243, v1, 4, s44
    v_and_b32 v244, 0xfffffe00, v243
    v_add_u32 v243, v243, v244
    s_mul_i32 s44, s31, 14336
    s_and_b32 s45, s30, 1
    s_lshl_b32 s45, s45, 9
    s_add_u32 s44, s44, s45
    s_lshr_b32 s45, s30, 1
    s_mul_i32 s45, s45, 458752
    s_add_u32 s44, s44, s45
    s_waitcnt vmcnt(6)
    v_mul_f32 v10, s40, v10
    v_mul_f32 v4, s40, v4
    v_exp_f32 v10, v10
    v_exp_f32 v4, v4
    s_nop 0
    v_cvt_pk_bf16_f32 v10, v10, v10
    v_and_b32 v10, 0xffff0000, v10
    v_cvt_pk_bf16_f32 v4, v4, v4
    v_and_b32 v4, 0xffff0000, v4
    s_waitcnt vmcnt(0)
    s_mov_b32 exec_hi, 0x00ffffff
    buffer_load_dwordx4 v[204:207], v240, s[72:75], s44 offen
    buffer_load_dwordx4 v[204:207], v243, s[72:75], s44 offen
    s_mov_b32 exec_hi, -1
    v_mul_f32 v4, v4, v10
    v_mul_f32 v5, v5, v10
    v_max3_f32 v18, |v6|, |v7|, |v8|
    v_mul_f32 v16, s40, v4
    v_max_f32 v18, |v9|, v18
    v_mul_f32 v17, s41, v5
    v_cndmask_b32 v70, 0, v70, vcc
    v_mul_f32 v26, -1.0, v16
    v_mul_f32 v27, 1.0, v17
    v_mul_f32 v28, -8.0, v16
    v_mul_f32 v29, 8.0, v17
    v_mul_f32 v30, -256.0, v16
    v_mul_f32 v31, 256.0, v17
    v_max_f32_dpp v18, v18, v18 row_shr:1 row_mask:0xf bank_mask:0xf
    v_exp_f32 v26, v26
    v_exp_f32 v28, v28
    v_exp_f32 v30, v30
    v_max_f32_dpp v18, v18, v18 row_shr:2 row_mask:0xf bank_mask:0xf
    v_fract_f32 v27, v27
    v_fract_f32 v29, v29
    v_fract_f32 v31, v31
    v_max_f32_dpp v18, v18, v18 row_shr:4 row_mask:0xf bank_mask:0xf
    v_cos_f32 v20, v27
    v_cos_f32 v22, v29
    v_cos_f32 v24, v31
    v_max_f32_dpp v18, v18, v18 row_shr:8 row_mask:0xf bank_mask:0xf
    v_sin_f32 v21, v27
    v_sin_f32 v23, v29
    v_sin_f32 v25, v31
    v_max_f32_dpp v18, v18, v18 row_bcast:15 row_mask:0xa bank_mask:0xf
    v_mul_f32 v20, v20, v26
    v_mul_f32 v22, v22, v28
    v_mul_f32 v24, v24, v30
    v_max_f32_dpp v18, v18, v18 row_bcast:31 row_mask:0xc bank_mask:0xf
    v_mul_f32 v21, v21, v26
    v_mul_f32 v23, v23, v28
    v_mul_f32 v25, v25, v30
    v_readlane_b32 s42, v18, 63
    v_mov_b32 v30, 0x3c00
    ds_write_addtid_b32 v30 offset:17408
    s_and_b32 s42, s42, 0x7f800000
    s_sub_u32 s43, 0x7f000000, s42
    v_mul_f32 v32, s43, v6
    v_mul_f32 v33, s43, v7
    v_mul_f32 v19, s42, v10
    v_add_f32 v19, v19, v19
    v_cvt_pk_f16_f32 v26, v22, v23
    v_cvt_pk_f16_f32 v28, v32, -v33
    ds_write_addtid_b32 v26 offset:17952
    ds_write_addtid_b32 v28 offset:0
    v_pk_mul_f32 v[50:51], v[22:23], v[22:23] op_sel:[0,0] op_sel_hi:[0,1]
    v_pk_mul_f32 v[34:35], v[32:33], v[20:21] op_sel:[0,0] op_sel_hi:[0,1]
    v_pk_fma_f32 v[50:51], v[22:23], v[22:23], v[50:51] op_sel:[1,1,0] op_sel_hi:[1,0,1] neg_lo:[1,0,0]
    v_pk_fma_f32 v[34:35], v[32:33], v[20:21], v[34:35] op_sel:[1,1,0] op_sel_hi:[1,0,1] neg_lo:[1,0,0]
    v_cvt_pk_f16_f32 v27, v50, v51
    v_cvt_pk_f16_f32 v29, v34, -v35
    ds_write_addtid_b32 v27 offset:18496
    ds_write_addtid_b32 v29 offset:544
    v_pk_mul_f32 v[52:53], v[50:51], v[22:23] op_sel:[0,0] op_sel_hi:[0,1]
    v_pk_mul_f32 v[36:37], v[34:35], v[20:21] op_sel:[0,0] op_sel_hi:[0,1]
    v_pk_fma_f32 v[52:53], v[50:51], v[22:23], v[52:53] op_sel:[1,1,0] op_sel_hi:[1,0,1] neg_lo:[1,0,0]
    v_pk_fma_f32 v[36:37], v[34:35], v[20:21], v[36:37] op_sel:[1,1,0] op_sel_hi:[1,0,1] neg_lo:[1,0,0]
    v_cvt_pk_f16_f32 v26, v52, v53
    v_cvt_pk_f16_f32 v28, v36, -v37
    ds_write_addtid_b32 v26 offset:19040
    ds_write_addtid_b32 v28 offset:1088
    v_pk_mul_f32 v[50:51], v[52:53], v[22:23] op_sel:[0,0] op_sel_hi:[0,1]
    v_pk_mul_f32 v[38:39], v[36:37], v[20:21] op_sel:[0,0] op_sel_hi:[0,1]
    v_pk_fma_f32 v[50:51], v[52:53], v[22:23], v[50:51] op_sel:[1,1,0] op_sel_hi:[1,0,1] neg_lo:[1,0,0]
    v_pk_fma_f32 v[38:39], v[36:37], v[20:21], v[38:39] op_sel:[1,1,0] op_sel_hi:[1,0,1] neg_lo:[1,0,0]
    v_cvt_pk_f16_f32 v27, v50, v51
    v_cvt_pk_f16_f32 v29, v38, -v39
    ds_write_addtid_b32 v27 offset:19584
    ds_write_addtid_b32 v29 offset:1632
    v_pk_mul_f32 v[52:53], v[50:51], v[22:23] op_sel:[0,0] op_sel_hi:[0,1]
    v_pk_mul_f32 v[40:41], v[38:39], v[20:21] op_sel:[0,0] op_sel_hi:[0,1]
    v_pk_fma_f32 v[52:53], v[50:51], v[22:23], v[52:53] op_sel:[1,1,0] op_sel_hi:[1,0,1] neg_lo:[1,0,0]
    v_pk_fma_f32 v[40:41], v[38:39], v[20:21], v[40:41] op_sel:[1,1,0] op_sel_hi:[1,0,1] neg_lo:[1,0,0]
    v_cvt_pk_f16_f32 v26, v52, v53
    v_cvt_pk_f16_f32 v28, v40, -v41
    ds_write_addtid_b32 v26 offset:20128
    ds_write_addtid_b32 v28 offset:8704
    v_pk_mul_f32 v[50:51], v[52:53], v[22:23] op_sel:[0,0] op_sel_hi:[0,1]
    v_pk_mul_f32 v[42:43], v[40:41], v[20:21] op_sel:[0,0] op_sel_hi:[0,1]
    v_pk_fma_f32 v[50:51], v[52:53], v[22:23], v[50:51] op_sel:[1,1,0] op_sel_hi:[1,0,1] neg_lo:[1,0,0]
    v_pk_fma_f32 v[42:43], v[40:41], v[20:21], v[42:43] op_sel:[1,1,0] op_sel_hi:[1,0,1] neg_lo:[1,0,0]
    v_cvt_pk_f16_f32 v27, v50, v51
    v_cvt_pk_f16_f32 v29, v42, -v43
    ds_write_addtid_b32 v27 offset:20672
    ds_write_addtid_b32 v29 offset:9248
    v_pk_mul_f32 v[52:53], v[50:51], v[22:23] op_sel:[0,0] op_sel_hi:[0,1]
    v_pk_mul_f32 v[44:45], v[42:43], v[20:21] op_sel:[0,0] op_sel_hi:[0,1]
    v_pk_fma_f32 v[52:53], v[50:51], v[22:23], v[52:53] op_sel:[1,1,0] op_sel_hi:[1,0,1] neg_lo:[1,0,0]
    v_pk_fma_f32 v[44:45], v[42:43], v[20:21], v[44:45] op_sel:[1,1,0] op_sel_hi:[1,0,1] neg_lo:[1,0,0]
    v_cvt_pk_f16_f32 v26, v52, v53
    v_cvt_pk_f16_f32 v28, v44, -v45
    ds_write_addtid_b32 v26 offset:21216
    ds_write_addtid_b32 v28 offset:9792
    v_pk_mul_f32 v[50:51], v[52:53], v[22:23] op_sel:[0,0] op_sel_hi:[0,1]
    v_pk_mul_f32 v[46:47], v[44:45], v[20:21] op_sel:[0,0] op_sel_hi:[0,1]
    v_pk_fma_f32 v[50:51], v[52:53], v[22:23], v[50:51] op_sel:[1,1,0] op_sel_hi:[1,0,1] neg_lo:[1,0,0]
    v_pk_fma_f32 v[46:47], v[44:45], v[20:21], v[46:47] op_sel:[1,1,0] op_sel_hi:[1,0,1] neg_lo:[1,0,0]
    v_cvt_pk_f16_f32 v27, v50, v51
    v_cvt_pk_f16_f32 v29, v46, -v47
    ds_write_addtid_b32 v27 offset:21760
    ds_write_addtid_b32 v29 offset:10336
    v_pk_mul_f32 v[52:53], v[50:51], v[22:23] op_sel:[0,0] op_sel_hi:[0,1]
    v_pk_mul_f32 v[48:49], v[46:47], v[20:21] op_sel:[0,0] op_sel_hi:[0,1]
    v_pk_fma_f32 v[52:53], v[50:51], v[22:23], v[52:53] op_sel:[1,1,0] op_sel_hi:[1,0,1] neg_lo:[1,0,0]
    v_pk_fma_f32 v[48:49], v[46:47], v[20:21], v[48:49] op_sel:[1,1,0] op_sel_hi:[1,0,1] neg_lo:[1,0,0]
    v_cvt_pk_f16_f32 v26, v52, v53
    v_pk_mul_f32 v[54:55], v[24:25], v[24:25] op_sel:[0,0] op_sel_hi:[0,1]
    ds_write_addtid_b32 v26 offset:22304
    v_pk_fma_f32 v[54:55], v[24:25], v[24:25], v[54:55] op_sel:[1,1,0] op_sel_hi:[1,0,1] neg_lo:[1,0,0]
    v_pk_mul_f32 v[50:51], v[52:53], v[22:23] op_sel:[0,0] op_sel_hi:[0,1]
    v_pk_mul_f32 v[56:57], v[54:55], v[24:25] op_sel:[0,0] op_sel_hi:[0,1]
    v_pk_fma_f32 v[50:51], v[52:53], v[22:23], v[50:51] op_sel:[1,1,0] op_sel_hi:[1,0,1] neg_lo:[1,0,0]
    v_pk_fma_f32 v[56:57], v[54:55], v[24:25], v[56:57] op_sel:[1,1,0] op_sel_hi:[1,0,1] neg_lo:[1,0,0]
    v_cvt_pk_f16_f32 v27, v50, v51
    v_pk_mul_f32 v[58:59], v[54:55], v[54:55] op_sel:[0,0] op_sel_hi:[0,1]
    ds_write_addtid_b32 v27 offset:22848
    v_pk_fma_f32 v[58:59], v[54:55], v[54:55], v[58:59] op_sel:[1,1,0] op_sel_hi:[1,0,1] neg_lo:[1,0,0]
    v_pk_mul_f32 v[52:53], v[50:51], v[22:23] op_sel:[0,0] op_sel_hi:[0,1]
    v_pk_mul_f32 v[60:61], v[58:59], v[24:25] op_sel:[0,0] op_sel_hi:[0,1]
    v_pk_fma_f32 v[52:53], v[50:51], v[22:23], v[52:53] op_sel:[1,1,0] op_sel_hi:[1,0,1] neg_lo:[1,0,0]
    v_pk_fma_f32 v[60:61], v[58:59], v[24:25], v[60:61] op_sel:[1,1,0] op_sel_hi:[1,0,1] neg_lo:[1,0,0]
    v_cvt_pk_f16_f32 v26, v52, v53
    v_pk_mul_f32 v[62:63], v[58:59], v[54:55] op_sel:[0,0] op_sel_hi:[0,1]
    ds_write_addtid_b32 v26 offset:23392
    v_pk_fma_f32 v[62:63], v[58:59], v[54:55], v[62:63] op_sel:[1,1,0] op_sel_hi:[1,0,1] neg_lo:[1,0,0]
    v_pk_mul_f32 v[50:51], v[52:53], v[22:23] op_sel:[0,0] op_sel_hi:[0,1]
    v_pk_mul_f32 v[64:65], v[58:59], v[56:57] op_sel:[0,0] op_sel_hi:[0,1]
    v_pk_fma_f32 v[50:51], v[52:53], v[22:23], v[50:51] op_sel:[1,1,0] op_sel_hi:[1,0,1] neg_lo:[1,0,0]
    v_pk_fma_f32 v[64:65], v[58:59], v[56:57], v[64:65] op_sel:[1,1,0] op_sel_hi:[1,0,1] neg_lo:[1,0,0]
    v_cvt_pk_f16_f32 v27, v50, v51
    v_pk_mul_f32 v[66:67], v[32:33], v[24:25] op_sel:[0,0] op_sel_hi:[0,1]
    ds_write_addtid_b32 v27 offset:23936
    v_pk_fma_f32 v[66:67], v[32:33], v[24:25], v[66:67] op_sel:[1,1,0] op_sel_hi:[1,0,1] neg_lo:[1,0,0]
    v_pk_mul_f32 v[52:53], v[50:51], v[22:23] op_sel:[0,0] op_sel_hi:[0,1]
    v_cvt_pk_f16_f32 v28, v66, -v67
    v_pk_fma_f32 v[52:53], v[50:51], v[22:23], v[52:53] op_sel:[1,1,0] op_sel_hi:[1,0,1] neg_lo:[1,0,0]
    ds_write_addtid_b32 v28 offset:2176
    v_cvt_pk_f16_f32 v26, v52, v53
    v_pk_mul_f32 v[68:69], v[36:37], v[24:25] op_sel:[0,0] op_sel_hi:[0,1]
    ds_write_addtid_b32 v26 offset:24480
    v_pk_fma_f32 v[68:69], v[36:37], v[24:25], v[68:69] op_sel:[1,1,0] op_sel_hi:[1,0,1] neg_lo:[1,0,0]
    v_pk_mul_f32 v[50:51], v[52:53], v[22:23] op_sel:[0,0] op_sel_hi:[0,1]
    v_cvt_pk_f16_f32 v29, v68, -v69
    v_pk_fma_f32 v[50:51], v[52:53], v[22:23], v[50:51] op_sel:[1,1,0] op_sel_hi:[1,0,1] neg_lo:[1,0,0]
    ds_write_addtid_b32 v29 offset:2720
    v_cvt_pk_f16_f32 v27, v50, v51
    v_pk_mul_f32 v[66:67], v[40:41], v[24:25] op_sel:[0,0] op_sel_hi:[0,1]
    ds_write_addtid_b32 v27 offset:25024
    v_pk_fma_f32 v[66:67], v[40:41], v[24:25], v[66:67] op_sel:[1,1,0] op_sel_hi:[1,0,1] neg_lo:[1,0,0]
    v_pk_mul_f32 v[52:53], v[50:51], v[22:23] op_sel:[0,0] op_sel_hi:[0,1]
    v_cvt_pk_f16_f32 v28, v66, -v67
    v_pk_fma_f32 v[52:53], v[50:51], v[22:23], v[52:53] op_sel:[1,1,0] op_sel_hi:[1,0,1] neg_lo:[1,0,0]
    ds_write_addtid_b32 v28 offset:3264
    v_cvt_pk_f16_f32 v26, v52, v53
    v_pk_mul_f32 v[68:69], v[44:45], v[24:25] op_sel:[0,0] op_sel_hi:[0,1]
    ds_write_addtid_b32 v26 offset:25568
    v_pk_fma_f32 v[68:69], v[44:45], v[24:25], v[68:69] op_sel:[1,1,0] op_sel_hi:[1,0,1] neg_lo:[1,0,0]
    v_pk_mul_f32 v[50:51], v[52:53], v[22:23] op_sel:[0,0] op_sel_hi:[0,1]
    v_cvt_pk_f16_f32 v29, v68, -v69
    v_pk_fma_f32 v[50:51], v[52:53], v[22:23], v[50:51] op_sel:[1,1,0] op_sel_hi:[1,0,1] neg_lo:[1,0,0]
    ds_write_addtid_b32 v29 offset:3808
    v_cvt_pk_f16_f32 v27, v50, v51
    v_pk_mul_f32 v[66:67], v[48:49], v[24:25] op_sel:[0,0] op_sel_hi:[0,1]
    ds_write_addtid_b32 v27 offset:26112
    v_pk_fma_f32 v[66:67], v[48:49], v[24:25], v[66:67] op_sel:[1,1,0] op_sel_hi:[1,0,1] neg_lo:[1,0,0]
    v_pk_mul_f32 v[52:53], v[50:51], v[22:23] op_sel:[0,0] op_sel_hi:[0,1]
    v_cvt_pk_f16_f32 v28, v66, -v67
    v_pk_fma_f32 v[52:53], v[50:51], v[22:23], v[52:53] op_sel:[1,1,0] op_sel_hi:[1,0,1] neg_lo:[1,0,0]
    ds_write_addtid_b32 v28 offset:10880
    v_cvt_pk_f16_f32 v26, v52, v53
    v_pk_mul_f32 v[68:69], v[32:33], v[54:55] op_sel:[0,0] op_sel_hi:[0,1]
    ds_write_addtid_b32 v26 offset:26656
    v_pk_fma_f32 v[68:69], v[32:33], v[54:55], v[68:69] op_sel:[1,1,0] op_sel_hi:[1,0,1] neg_lo:[1,0,0]
    v_pk_mul_f32 v[50:51], v[52:53], v[22:23] op_sel:[0,0] op_sel_hi:[0,1]
    v_cvt_pk_f16_f32 v29, v68, -v69
    v_pk_fma_f32 v[50:51], v[52:53], v[22:23], v[50:51] op_sel:[1,1,0] op_sel_hi:[1,0,1] neg_lo:[1,0,0]
    ds_write_addtid_b32 v29 offset:4352
    v_cvt_pk_f16_f32 v27, v50, v51
    v_pk_mul_f32 v[66:67], v[40:41], v[54:55] op_sel:[0,0] op_sel_hi:[0,1]
    ds_write_addtid_b32 v27 offset:27200
    v_pk_fma_f32 v[66:67], v[40:41], v[54:55], v[66:67] op_sel:[1,1,0] op_sel_hi:[1,0,1] neg_lo:[1,0,0]
    v_pk_mul_f32 v[52:53], v[50:51], v[22:23] op_sel:[0,0] op_sel_hi:[0,1]
    v_cvt_pk_f16_f32 v28, v66, -v67
    v_pk_fma_f32 v[52:53], v[50:51], v[22:23], v[52:53] op_sel:[1,1,0] op_sel_hi:[1,0,1] neg_lo:[1,0,0]
    ds_write_addtid_b32 v28 offset:4896
    v_cvt_pk_f16_f32 v26, v52, v53
    v_pk_mul_f32 v[68:69], v[48:49], v[54:55] op_sel:[0,0] op_sel_hi:[0,1]
    ds_write_addtid_b32 v26 offset:27744
    v_pk_fma_f32 v[68:69], v[48:49], v[54:55], v[68:69] op_sel:[1,1,0] op_sel_hi:[1,0,1] neg_lo:[1,0,0]
    v_pk_mul_f32 v[50:51], v[52:53], v[22:23] op_sel:[0,0] op_sel_hi:[0,1]
    v_cvt_pk_f16_f32 v29, v68, -v69
    v_pk_fma_f32 v[50:51], v[52:53], v[22:23], v[50:51] op_sel:[1,1,0] op_sel_hi:[1,0,1] neg_lo:[1,0,0]
    ds_write_addtid_b32 v29 offset:5440
    v_cvt_pk_f16_f32 v27, v50, v51
    v_pk_mul_f32 v[66:67], v[32:33], v[56:57] op_sel:[0,0] op_sel_hi:[0,1]
    ds_write_addtid_b32 v27 offset:28288
    v_pk_fma_f32 v[66:67], v[32:33], v[56:57], v[66:67] op_sel:[1,1,0] op_sel_hi:[1,0,1] neg_lo:[1,0,0]
    v_pk_mul_f32 v[52:53], v[50:51], v[22:23] op_sel:[0,0] op_sel_hi:[0,1]
    v_cvt_pk_f16_f32 v28, v66, -v67
    v_pk_fma_f32 v[52:53], v[50:51], v[22:23], v[52:53] op_sel:[1,1,0] op_sel_hi:[1,0,1] neg_lo:[1,0,0]
    ds_write_addtid_b32 v28 offset:13056
    v_cvt_pk_f16_f32 v26, v52, v53
    v_pk_mul_f32 v[68:69], v[40:41], v[56:57] op_sel:[0,0] op_sel_hi:[0,1]
    ds_write_addtid_b32 v26 offset:28832
    v_pk_fma_f32 v[68:69], v[40:41], v[56:57], v[68:69] op_sel:[1,1,0] op_sel_hi:[1,0,1] neg_lo:[1,0,0]
    v_pk_mul_f32 v[50:51], v[52:53], v[22:23] op_sel:[0,0] op_sel_hi:[0,1]
    v_cvt_pk_f16_f32 v29, v68, -v69
    v_pk_fma_f32 v[50:51], v[52:53], v[22:23], v[50:51] op_sel:[1,1,0] op_sel_hi:[1,0,1] neg_lo:[1,0,0]
    ds_write_addtid_b32 v29 offset:13600
    v_cvt_pk_f16_f32 v27, v50, v51
    v_pk_mul_f32 v[66:67], v[48:49], v[56:57] op_sel:[0,0] op_sel_hi:[0,1]
    ds_write_addtid_b32 v27 offset:29376
    v_pk_fma_f32 v[66:67], v[48:49], v[56:57], v[66:67] op_sel:[1,1,0] op_sel_hi:[1,0,1] neg_lo:[1,0,0]
    v_pk_mul_f32 v[52:53], v[50:51], v[22:23] op_sel:[0,0] op_sel_hi:[0,1]
    v_cvt_pk_f16_f32 v28, v66, -v67
    v_pk_fma_f32 v[52:53], v[50:51], v[22:23], v[52:53] op_sel:[1,1,0] op_sel_hi:[1,0,1] neg_lo:[1,0,0]
    ds_write_addtid_b32 v28 offset:14144
    v_cvt_pk_f16_f32 v26, v52, v53
    v_pk_mul_f32 v[68:69], v[32:33], v[58:59] op_sel:[0,0] op_sel_hi:[0,1]
    ds_write_addtid_b32 v26 offset:29920
    v_pk_fma_f32 v[68:69], v[32:33], v[58:59], v[68:69] op_sel:[1,1,0] op_sel_hi:[1,0,1] neg_lo:[1,0,0]
    v_pk_mul_f32 v[50:51], v[52:53], v[22:23] op_sel:[0,0] op_sel_hi:[0,1]
    v_cvt_pk_f16_f32 v29, v68, -v69
    v_pk_fma_f32 v[50:51], v[52:53], v[22:23], v[50:51] op_sel:[1,1,0] op_sel_hi:[1,0,1] neg_lo:[1,0,0]
    ds_write_addtid_b32 v29 offset:6528
    v_cvt_pk_f16_f32 v27, v50, v51
    v_pk_mul_f32 v[66:67], v[48:49], v[58:59] op_sel:[0,0] op_sel_hi:[0,1]
    ds_write_addtid_b32 v27 offset:30464
    v_pk_fma_f32 v[66:67], v[48:49], v[58:59], v[66:67] op_sel:[1,1,0] op_sel_hi:[1,0,1] neg_lo:[1,0,0]
    v_pk_mul_f32 v[52:53], v[50:51], v[22:23] op_sel:[0,0] op_sel_hi:[0,1]
    v_cvt_pk_f16_f32 v28, v66, -v67
    v_pk_fma_f32 v[52:53], v[50:51], v[22:23], v[52:53] op_sel:[1,1,0] op_sel_hi:[1,0,1] neg_lo:[1,0,0]
    ds_write_addtid_b32 v28 offset:15232
    v_cvt_pk_f16_f32 v26, v52, v53
    v_pk_mul_f32 v[68:69], v[32:33], v[60:61] op_sel:[0,0] op_sel_hi:[0,1]
    ds_write_addtid_b32 v26 offset:31008
    v_pk_fma_f32 v[68:69], v[32:33], v[60:61], v[68:69] op_sel:[1,1,0] op_sel_hi:[1,0,1] neg_lo:[1,0,0]
    v_pk_mul_f32 v[50:51], v[52:53], v[22:23] op_sel:[0,0] op_sel_hi:[0,1]
    v_cvt_pk_f16_f32 v29, v68, -v69
    v_pk_fma_f32 v[50:51], v[52:53], v[22:23], v[50:51] op_sel:[1,1,0] op_sel_hi:[1,0,1] neg_lo:[1,0,0]
    ds_write_addtid_b32 v29 offset:7072
    v_cvt_pk_f16_f32 v27, v50, v51
    v_pk_mul_f32 v[66:67], v[48:49], v[60:61] op_sel:[0,0] op_sel_hi:[0,1]
    ds_write_addtid_b32 v27 offset:31552
    v_pk_fma_f32 v[66:67], v[48:49], v[60:61], v[66:67] op_sel:[1,1,0] op_sel_hi:[1,0,1] neg_lo:[1,0,0]
    v_pk_mul_f32 v[52:53], v[50:51], v[22:23] op_sel:[0,0] op_sel_hi:[0,1]
    v_cvt_pk_f16_f32 v28, v66, -v67
    v_pk_fma_f32 v[52:53], v[50:51], v[22:23], v[52:53] op_sel:[1,1,0] op_sel_hi:[1,0,1] neg_lo:[1,0,0]
    ds_write_addtid_b32 v28 offset:15776
    v_cvt_pk_f16_f32 v26, v52, v53
    v_pk_mul_f32 v[68:69], v[32:33], v[62:63] op_sel:[0,0] op_sel_hi:[0,1]
    ds_write_addtid_b32 v26 offset:32096
    v_pk_fma_f32 v[68:69], v[32:33], v[62:63], v[68:69] op_sel:[1,1,0] op_sel_hi:[1,0,1] neg_lo:[1,0,0]
    v_pk_mul_f32 v[50:51], v[52:53], v[22:23] op_sel:[0,0] op_sel_hi:[0,1]
    v_cvt_pk_f16_f32 v29, v68, -v69
    v_pk_fma_f32 v[50:51], v[52:53], v[22:23], v[50:51] op_sel:[1,1,0] op_sel_hi:[1,0,1] neg_lo:[1,0,0]
    ds_write_addtid_b32 v29 offset:7616
    v_cvt_pk_f16_f32 v27, v50, v51
    v_pk_mul_f32 v[66:67], v[48:49], v[62:63] op_sel:[0,0] op_sel_hi:[0,1]
    ds_write_addtid_b32 v27 offset:32640
    v_pk_fma_f32 v[66:67], v[48:49], v[62:63], v[66:67] op_sel:[1,1,0] op_sel_hi:[1,0,1] neg_lo:[1,0,0]
    v_pk_mul_f32 v[52:53], v[50:51], v[22:23] op_sel:[0,0] op_sel_hi:[0,1]
    v_cvt_pk_f16_f32 v28, v66, -v67
    v_pk_fma_f32 v[52:53], v[50:51], v[22:23], v[52:53] op_sel:[1,1,0] op_sel_hi:[1,0,1] neg_lo:[1,0,0]
    ds_write_addtid_b32 v28 offset:16320
    v_cvt_pk_f16_f32 v26, v52, v53
    v_pk_mul_f32 v[68:69], v[32:33], v[64:65] op_sel:[0,0] op_sel_hi:[0,1]
    ds_write_addtid_b32 v26 offset:33184
    v_pk_fma_f32 v[68:69], v[32:33], v[64:65], v[68:69] op_sel:[1,1,0] op_sel_hi:[1,0,1] neg_lo:[1,0,0]
    v_pk_mul_f32 v[50:51], v[52:53], v[22:23] op_sel:[0,0] op_sel_hi:[0,1]
    v_cvt_pk_f16_f32 v29, v68, -v69
    v_pk_fma_f32 v[50:51], v[52:53], v[22:23], v[50:51] op_sel:[1,1,0] op_sel_hi:[1,0,1] neg_lo:[1,0,0]
    ds_write_addtid_b32 v29 offset:8160
    v_cvt_pk_f16_f32 v27, v50, v51
    v_pk_mul_f32 v[66:67], v[48:49], v[64:65] op_sel:[0,0] op_sel_hi:[0,1]
    ds_write_addtid_b32 v27 offset:33728
    v_pk_fma_f32 v[66:67], v[48:49], v[64:65], v[66:67] op_sel:[1,1,0] op_sel_hi:[1,0,1] neg_lo:[1,0,0]
    v_pk_mul_f32 v[52:53], v[50:51], v[22:23] op_sel:[0,0] op_sel_hi:[0,1]
    v_cvt_pk_f16_f32 v28, v66, -v67
    v_pk_fma_f32 v[52:53], v[50:51], v[22:23], v[52:53] op_sel:[1,1,0] op_sel_hi:[1,0,1] neg_lo:[1,0,0]
    ds_write_addtid_b32 v28 offset:16864
    v_cvt_pk_f16_f32 v26, v52, v53
    ds_write_addtid_b32 v26 offset:34272
    v_mov_b32 v2, 1
    v_xor_b32 v3, 4, v203
    s_mov_b32 s54, 0
    s_waitcnt lgkmcnt(0)
    ds_write_b32 v203, v2
kf_kernel_ts:
    ds_read_b32 v12, v3
    s_add_u32 s54, s54, 1
    s_cmp_gt_u32 s54, 65536
    s_cbranch_scc1 kf_kernel_tso
    s_waitcnt lgkmcnt(0)
    v_cmp_gt_u32 vcc, 1, v12
    s_cbranch_vccnz kf_kernel_ts
kf_kernel_tso:
    ds_read_b128 v[80:83], v14 offset:0
    ds_read_b128 v[72:75], v13 offset:0
    ds_read_b128 v[76:79], v13 offset:8704
    ds_read_b128 v[92:95], v14 offset:64
    ds_read_b128 v[84:87], v13 offset:64
    ds_read_b128 v[88:91], v13 offset:8768
    ds_read_b128 v[104:107], v14 offset:128
    ds_read_b128 v[96:99], v13 offset:128
    ds_read_b128 v[100:103], v13 offset:8832
    ds_read_b128 v[116:119], v14 offset:192
    ds_read_b128 v[108:111], v13 offset:192
    ds_read_b128 v[112:115], v13 offset:8896
    v_lshlrev_b32 v202, 4, v1
    v_and_b32 v3, 15, v1
    v_lshrrev_b32 v2, 4, v1
    s_mul_i32 s39, s33, 4672
    s_add_u32 s39, s39, 98304
    v_and_b32 v12, 1, v1
    v_mul_u32_u24 v197, 4160, v12
    v_lshl_add_u32 v197, v2, 4, v197
    v_lshrrev_b32 v12, 1, v3
    v_lshlrev_b32 v12, 2, v12
    v_sub_u32 v197, v197, v12
    s_lshl_b32 s36, s34, 8
    s_sub_u32 s36, 284, s36
    s_add_u32 s36, s36, s46
    v_add_u32 v197, s36, v197
    v_add_u32 v198, 1024, v197
    v_add_u32 v199, 2048, v197
    v_add_u32 v200, 3072, v197
    v_lshlrev_b32 v192, 5, v3
    v_lshl_add_u32 v192, v2, 4, v192
    s_lshl_b32 s36, s34, 8
    s_sub_u32 s36, 288, s36
    s_add_u32 s36, s36, s39
    v_add_u32 v192, s36, v192
    s_lshl_b32 s36, s20, 12
    s_add_u32 s37, s36, 141888
    v_add_u32 v193, s37, v202
    s_xor_b32 s36, s36, 4096
    s_add_u32 s37, s36, 141888
    v_add_u32 v194, s37, v202
    s_mul_i32 s36, s20, 4384
    s_add_u32 s36, s36, 124352
    v_lshl_add_u32 v196, v2, 4, v202
    v_add_u32 v196, s36, v196
    v_mov_b32 v201, 161280
    v_lshrrev_b32 v12, 3, v3
    v_lshlrev_b32 v195, 17, v12
    v_and_b32 v12, 7, v3
    v_lshl_add_u32 v195, v12, 5, v195
    v_and_b32 v12, 1, v2
    v_lshl_add_u32 v195, v12, 18, v195
    v_lshrrev_b32 v12, 1, v2
    v_lshl_add_u32 v195, v12, 4, v195
    s_lshl_b32 s47, s35, 8
    s_lshl_b32 s36, s34, 19
    s_add_u32 s47, s47, s36
    s_add_u32 s47, s47, 0x800000
    s_waitcnt lgkmcnt(9)
    v_mfma_f32_16x16x32_f16 v[4:7], v[72:75], v[80:83], 0
    v_mfma_f32_16x16x32_f16 v[8:11], v[76:79], v[80:83], 0
    ds_read_b128 v[128:131], v14 offset:256
    ds_read_b128 v[120:123], v13 offset:256
    ds_read_b128 v[124:127], v13 offset:8960
    s_waitcnt lgkmcnt(9)
    v_mfma_f32_16x16x32_f16 v[4:7], v[84:87], v[92:95], v[4:7]
    v_mfma_f32_16x16x32_f16 v[8:11], v[88:91], v[92:95], v[8:11]
    ds_read_b128 v[140:143], v14 offset:320
    ds_read_b128 v[132:135], v13 offset:320
    ds_read_b128 v[136:139], v13 offset:9024
    s_waitcnt lgkmcnt(9)
    v_mfma_f32_16x16x32_f16 v[4:7], v[96:99], v[104:107], v[4:7]
    v_mfma_f32_16x16x32_f16 v[8:11], v[100:103], v[104:107], v[8:11]
    ds_read_b128 v[152:155], v14 offset:384
    ds_read_b128 v[144:147], v13 offset:384
    ds_read_b128 v[148:151], v13 offset:9088
    s_waitcnt lgkmcnt(9)
    v_mfma_f32_16x16x32_f16 v[4:7], v[108:111], v[116:119], v[4:7]
    v_mfma_f32_16x16x32_f16 v[8:11], v[112:115], v[116:119], v[8:11]
    ds_read_b128 v[164:167], v14 offset:448
    ds_read_b128 v[156:159], v13 offset:448
    ds_read_b128 v[160:163], v13 offset:9152
    s_waitcnt lgkmcnt(9)
    v_mfma_f32_16x16x32_f16 v[4:7], v[120:123], v[128:131], v[4:7]
    v_mfma_f32_16x16x32_f16 v[8:11], v[124:127], v[128:131], v[8:11]
    s_waitcnt lgkmcnt(6)
    v_mfma_f32_16x16x32_f16 v[4:7], v[132:135], v[140:143], v[4:7]
    v_mfma_f32_16x16x32_f16 v[8:11], v[136:139], v[140:143], v[8:11]
    s_waitcnt lgkmcnt(3)
    v_mfma_f32_16x16x32_f16 v[4:7], v[144:147], v[152:155], v[4:7]
    v_mfma_f32_16x16x32_f16 v[8:11], v[148:151], v[152:155], v[8:11]
    s_waitcnt lgkmcnt(0)
    v_mfma_f32_16x16x32_f16 v[4:7], v[156:159], v[164:167], v[4:7]
    v_mfma_f32_16x16x32_f16 v[8:11], v[160:163], v[164:167], v[8:11]
    v_and_b32 v2, 1, v1
    v_cmp_eq_u32 vcc, 0, v2
    s_nop 6
    v_fma_f32 v4, v4, v19, v70
    v_mul_f32 v5, v5, v19
    v_mul_f32 v6, v6, v19
    v_mul_f32 v7, v7, v19
    v_mul_f32 v8, v8, v19
    v_mul_f32 v9, v9, v19
    v_mul_f32 v10, v10, v19
    v_mul_f32 v11, v11, v19
    s_cmp_eq_u32 s34, 0
    s_cselect_b32 s49, -1, 0x7fffffff
    s_mov_b32 exec_lo, 0
    s_mov_b32 exec_hi, 0xffff0000
    v_cndmask_b32 v26, v8, v4, vcc
    v_cvt_pk_bf16_f32 v32, v8, v8
    v_cvt_pk_bf16_f32 v34, v4, v4
    v_cvt_pk_bf16_f32 v33, v8, v26
    v_cvt_pk_bf16_f32 v35, v4, v4
    s_mov_b32 exec_hi, 0xffff
    v_cvt_pk_bf16_f32 v32, v6, v6
    v_cvt_pk_bf16_f32 v33, v5, v5
    v_cvt_pk_bf16_f32 v34, v5, v4
    v_cvt_pk_bf16_f32 v35, v4, v4
    s_mov_b32 exec_hi, -1
    s_mov_b32 exec_lo, 0xffff0000
    s_mov_b32 exec_hi, 0
    v_cvt_pk_bf16_f32 v32, v8, v7
    v_cvt_pk_bf16_f32 v33, v6, v6
    v_cvt_pk_bf16_f32 v34, v6, v5
    v_cvt_pk_bf16_f32 v35, v4, v4
    s_mov_b32 exec_lo, 0xffff
    v_cvt_pk_bf16_f32 v32, v11, v10
    v_cvt_pk_bf16_f32 v33, v9, v8
    v_cvt_pk_bf16_f32 v34, v7, v6
    v_cvt_pk_bf16_f32 v35, v5, v4
    s_mov_b64 exec, -1
    ds_write_b128 v15, v[32:35] offset:5698
    v_alignbit_b32 v36, v33, v32, 16
    v_alignbit_b32 v37, v34, v33, 16
    v_alignbit_b32 v38, v35, v34, 16
    v_mov_b32 v39, v35
    s_mov_b32 exec_hi, 0
    ds_write_b96 v15, v[36:38] offset:1538
    ds_write_b16_d16_hi v15, v35 offset:1550
    s_mov_b32 exec_lo, s49
    ds_write_b16 v15, v32 offset:1536
    s_mov_b32 exec_lo, 0
    s_mov_b32 exec_hi, -1
    ds_write_b128 v15, v[36:39] offset:1538
    s_mov_b32 exec_lo, 0
    s_mov_b32 exec_hi, 0xffff0000
    v_cndmask_b32 v26, v9, v5, vcc
    v_cvt_pk_bf16_f32 v40, v9, v9
    v_cvt_pk_bf16_f32 v42, v5, v5
    v_cvt_pk_bf16_f32 v41, v9, v26
    v_cvt_pk_bf16_f32 v43, v5, v5
    s_mov_b32 exec_hi, 0xffff
    v_cvt_pk_bf16_f32 v40, v10, v10
    v_cvt_pk_bf16_f32 v41, v9, v9
    v_cvt_pk_bf16_f32 v42, v9, v8
    v_cvt_pk_bf16_f32 v43, v8, v8
    s_mov_b32 exec_hi, -1
    ds_write_b128 v15, v[40:43] offset:5186
    v_alignbit_b32 v44, v41, v40, 16
    v_alignbit_b32 v45, v42, v41, 16
    v_alignbit_b32 v46, v43, v42, 16
    v_mov_b32 v47, v43
    ds_write_b128 v15, v[44:47] offset:1026
    s_mov_b32 exec_lo, 0
    s_mov_b32 exec_hi, 0xffff0000
    v_cndmask_b32 v26, v10, v6, vcc
    v_cvt_pk_bf16_f32 v48, v10, v10
    v_cvt_pk_bf16_f32 v50, v6, v6
    v_cvt_pk_bf16_f32 v49, v10, v26
    v_cvt_pk_bf16_f32 v51, v6, v6
    ds_write_b128 v15, v[48:51] offset:4674
    v_alignbit_b32 v52, v49, v48, 16
    v_alignbit_b32 v53, v50, v49, 16
    v_alignbit_b32 v54, v51, v50, 16
    v_mov_b32 v55, v51
    ds_write_b128 v15, v[52:55] offset:514
    s_mov_b32 exec_lo, 0
    s_mov_b32 exec_hi, 0xffff0000
    v_cndmask_b32 v26, v11, v7, vcc
    v_cvt_pk_bf16_f32 v56, v11, v11
    v_cvt_pk_bf16_f32 v58, v7, v7
    v_cvt_pk_bf16_f32 v57, v11, v26
    v_cvt_pk_bf16_f32 v59, v7, v7
    ds_write_b128 v15, v[56:59] offset:4162
    v_alignbit_b32 v60, v57, v56, 16
    v_alignbit_b32 v61, v58, v57, 16
    v_alignbit_b32 v62, v59, v58, 16
    v_mov_b32 v63, v59
    ds_write_b128 v15, v[60:63] offset:2
    s_mov_b64 exec, -1
    s_load_dwordx2 s[18:19], s[0:1], 80
    s_bfe_u32 s48, s32, 0x10003
    s_lshl_b32 s48, s48, 1
    s_and_b32 s36, s32, 1
    s_add_u32 s48, s48, s36
    s_lshl_b32 s48, s48, 4
    s_lshr_b32 s36, s32, 4
    s_add_u32 s48, s48, s36
    s_lshl_b32 s48, s48, 2
    s_bfe_u32 s36, s32, 0x20001
    s_add_u32 s48, s48, s36
    s_lshl_b32 s48, s48, 4
    s_add_u32 s48, s48, 0x1160000
    s_mul_i32 s36, s20, 4160
    s_add_u32 s36, s36, 111808
    v_add_u32 v12, s36, v202
    s_add_u32 s36, s46, 4094
    v_mov_b32 v13, s36
    v_mov_b64 v[48:49], 0
    v_mov_b64 v[50:51], 0
    s_mov_b64 exec, 0xf
    ds_write_b128 v12, v[48:51]
    ds_write_b16 v13, v48
    s_mov_b64 exec, -1
    v_mov_b32 v2, 2
    v_xor_b32 v3, 4, v203
    ds_write_b32 v203, v2
    s_mul_i32 s36, s31, 37
    s_lshr_b32 s36, s36, 8
    s_mul_i32 s37, s36, 7
    s_sub_u32 s37, s31, s37
    s_lshr_b32 s38, s30, 1
    s_lshl_b32 s38, s38, 2
    s_add_u32 s6, s38, s36
    s_mov_b32 s4, 0
    s_lshl_b32 s8, s38, 1
    s_lshr_b32 s36, s31, 2
    s_add_u32 s8, s8, s36
    s_and_b32 s38, s30, 1
    s_mul_i32 s36, s38, 7
    s_add_u32 s7, s36, s37
    s_lshl_b32 s38, s38, 2
    s_and_b32 s36, s31, 3
    s_add_u32 s9, s38, s36
    s_lshr_b32 s37, s31, 2
    s_lshl_b32 s36, s36, 1
    s_add_u32 s36, s36, s37
    s_mov_b32 s5, 0
    s_waitcnt lgkmcnt(0)
    s_mov_b32 s54, 0
kf_kernel_tm:
    ds_read_b32 v12, v3
    s_add_u32 s54, s54, 1
    s_cmp_gt_u32 s54, 65536
    s_cbranch_scc1 kf_kernel_tmo
    s_waitcnt lgkmcnt(0)
    v_cmp_gt_u32 vcc, 2, v12
    s_cbranch_vccnz kf_kernel_tm
kf_kernel_tmo:
    ds_read2_b32 v[64:65], v200 offset0:176 offset1:177
    ds_read2_b32 v[66:67], v200 offset0:178 offset1:179
    ds_read2_b32 v[68:69], v200 offset0:48 offset1:49
    ds_read2_b32 v[70:71], v200 offset0:50 offset1:51
    ds_read2_b32 v[72:73], v199 offset0:176 offset1:177
    ds_read2_b32 v[74:75], v199 offset0:178 offset1:179
    ds_read2_b32 v[76:77], v199 offset0:48 offset1:49
    ds_read2_b32 v[78:79], v199 offset0:50 offset1:51
    ds_read2_b32 v[80:81], v198 offset0:176 offset1:177
    ds_read2_b32 v[82:83], v198 offset0:178 offset1:179
    ds_read2_b32 v[84:85], v198 offset0:48 offset1:49
    ds_read2_b32 v[86:87], v198 offset0:50 offset1:51
    ds_read2_b32 v[88:89], v197 offset0:176 offset1:177
    ds_read2_b32 v[90:91], v197 offset0:178 offset1:179
    ds_read2_b32 v[92:93], v197 offset0:48 offset1:49
    s_waitcnt lgkmcnt(8)
    ds_read2_b32 v[94:95], v197 offset0:50 offset1:51
    ds_read2_b32 v[96:97], v200 offset0:160 offset1:161
    ds_read2_b32 v[98:99], v200 offset0:162 offset1:163
    ds_read2_b32 v[100:101], v200 offset0:32 offset1:33
    ds_read2_b32 v[102:103], v200 offset0:34 offset1:35
    ds_read2_b32 v[104:105], v199 offset0:160 offset1:161
    ds_read2_b32 v[106:107], v199 offset0:162 offset1:163
    s_waitcnt lgkmcnt(8)
    ds_read2_b32 v[108:109], v199 offset0:32 offset1:33
    ds_read2_b32 v[110:111], v199 offset0:34 offset1:35
    ds_read2_b32 v[112:113], v198 offset0:160 offset1:161
    ds_read2_b32 v[114:115], v198 offset0:162 offset1:163
    ds_read2_b32 v[116:117], v198 offset0:32 offset1:33
    ds_read2_b32 v[118:119], v198 offset0:34 offset1:35
    ds_read2_b32 v[120:121], v197 offset0:160 offset1:161
    s_waitcnt lgkmcnt(8)
    ds_read2_b32 v[122:123], v197 offset0:162 offset1:163
    ds_read2_b32 v[124:125], v197 offset0:32 offset1:33
    ds_read2_b32 v[126:127], v197 offset0:34 offset1:35
    s_waitcnt lgkmcnt(0)
    s_barrier
    s_setprio 1
    s_cmp_eq_u32 s20, 3
    s_cselect_b32 s22, s2, 224
    v_lshrrev_b32 v241, 3, v1
    v_and_b32 v242, 7, v1
    v_mul_u32_u24 v241, 3584, v241
    v_lshl_add_u32 v241, v242, 4, v241
    s_cmp_ge_u32 s22, 224
    s_cbranch_scc1 kf_kernel_ncs1
    s_lshr_b32 s50, s30, 1
    s_mul_i32 s50, s50, 28
    s_add_u32 s50, s50, s31
    s_mul_i32 s51, s50, 586
    s_lshr_b32 s51, s51, 13
    s_mul_i32 s52, s51, 14
    s_sub_u32 s50, s50, s52
    s_and_b32 s52, s30, 1
    s_mul_i32 s52, s52, 14
    s_add_u32 s50, s50, s52
    s_mul_i32 s52, s51, 229376
    s_lshl_b32 s53, s50, 7
    s_add_u32 s52, s52, s53
    buffer_load_dwordx4 v[208:211], v241, s[68:71], s52 offen
    s_add_u32 s52, s52, 28672
    buffer_load_dwordx4 v[212:215], v241, s[68:71], s52 offen
    s_add_u32 s52, s52, 28672
    buffer_load_dwordx4 v[216:219], v241, s[68:71], s52 offen
    s_add_u32 s52, s52, 28672
    buffer_load_dwordx4 v[220:223], v241, s[68:71], s52 offen
    s_add_u32 s52, s52, 28672
    buffer_load_dwordx4 v[224:227], v241, s[68:71], s52 offen
    s_add_u32 s52, s52, 28672
    buffer_load_dwordx4 v[228:231], v241, s[68:71], s52 offen
    s_add_u32 s52, s52, 28672
    buffer_load_dwordx4 v[232:235], v241, s[68:71], s52 offen
    s_add_u32 s52, s52, 28672
    buffer_load_dwordx4 v[236:239], v241, s[68:71], s52 offen
    s_mul_i32 s51, s51, 14336
    s_lshl_b32 s50, s50, 9
    s_add_u32 s23, s51, s50
    s_add_u32 s23, s23, 0x1120000
kf_kernel_ncs1:
    ds_read_b128 v[48:51], v192 offset:192
    ds_read_b128 v[52:55], v192 offset:704
    ds_read_b128 v[56:59], v192 offset:1216
    ds_read_b128 v[60:63], v192 offset:1728
    ds_read_b128 v[240:243], v192 offset:2240
    ds_read_b128 v[244:247], v192 offset:2752
    ds_read_b128 v[248:251], v192 offset:3264
    ds_read_b128 v[252:255], v192 offset:3776
    s_waitcnt lgkmcnt(7)
    v_mfma_f32_16x16x32_bf16 v[16:19], v[64:67], v[48:51], 0
    v_mfma_f32_16x16x32_bf16 v[20:23], v[68:71], v[48:51], 0
    v_mfma_f32_16x16x32_bf16 v[24:27], v[72:75], v[48:51], 0
    ds_read2_b32 v[128:129], v200 offset0:144 offset1:145
    v_mfma_f32_16x16x32_bf16 v[28:31], v[76:79], v[48:51], 0
    ds_read2_b32 v[130:131], v200 offset0:146 offset1:147
    v_mfma_f32_16x16x32_bf16 v[32:35], v[80:83], v[48:51], 0
    ds_read2_b32 v[132:133], v200 offset0:16 offset1:17
    v_mfma_f32_16x16x32_bf16 v[36:39], v[84:87], v[48:51], 0
    ds_read2_b32 v[134:135], v200 offset0:18 offset1:19
    v_mfma_f32_16x16x32_bf16 v[40:43], v[88:91], v[48:51], 0
    ds_read2_b32 v[136:137], v199 offset0:144 offset1:145
    v_mfma_f32_16x16x32_bf16 v[44:47], v[92:95], v[48:51], 0
    ds_read2_b32 v[138:139], v199 offset0:146 offset1:147
    ds_read_b128 v[48:51], v192 offset:128
    s_waitcnt lgkmcnt(13)
    v_mfma_f32_16x16x32_bf16 v[20:23], v[64:67], v[52:55], v[20:23]
    ds_read2_b32 v[140:141], v199 offset0:16 offset1:17
    v_mfma_f32_16x16x32_bf16 v[24:27], v[68:71], v[52:55], v[24:27]
    ds_read2_b32 v[142:143], v199 offset0:18 offset1:19
    v_mfma_f32_16x16x32_bf16 v[28:31], v[72:75], v[52:55], v[28:31]
    s_waitcnt lgkmcnt(8)
    ds_read2_b32 v[144:145], v198 offset0:144 offset1:145
    v_mfma_f32_16x16x32_bf16 v[32:35], v[76:79], v[52:55], v[32:35]
    ds_read2_b32 v[146:147], v198 offset0:146 offset1:147
    v_mfma_f32_16x16x32_bf16 v[36:39], v[80:83], v[52:55], v[36:39]
    ds_read2_b32 v[148:149], v198 offset0:16 offset1:17
    v_mfma_f32_16x16x32_bf16 v[40:43], v[84:87], v[52:55], v[40:43]
    ds_read2_b32 v[150:151], v198 offset0:18 offset1:19
    v_mfma_f32_16x16x32_bf16 v[44:47], v[88:91], v[52:55], v[44:47]
    ds_read2_b32 v[152:153], v197 offset0:144 offset1:145
    ds_read_b128 v[52:55], v192 offset:640
    v_mfma_f32_16x16x32_bf16 v[24:27], v[64:67], v[56:59], v[24:27]
    ds_read2_b32 v[154:155], v197 offset0:146 offset1:147
    v_mfma_f32_16x16x32_bf16 v[28:31], v[68:71], v[56:59], v[28:31]
    s_waitcnt lgkmcnt(8)
    ds_read2_b32 v[156:157], v197 offset0:16 offset1:17
    v_mfma_f32_16x16x32_bf16 v[32:35], v[72:75], v[56:59], v[32:35]
    ds_read2_b32 v[158:159], v197 offset0:18 offset1:19
    v_mfma_f32_16x16x32_bf16 v[36:39], v[76:79], v[56:59], v[36:39]
    ds_read2_b32 v[160:161], v200 offset0:128 offset1:129
    v_mfma_f32_16x16x32_bf16 v[40:43], v[80:83], v[56:59], v[40:43]
    ds_read2_b32 v[162:163], v200 offset0:130 offset1:131
    v_mfma_f32_16x16x32_bf16 v[44:47], v[84:87], v[56:59], v[44:47]
    ds_read2_b32 v[164:165], v200 offset0:0 offset1:1
    ds_read_b128 v[56:59], v192 offset:1152
    v_mfma_f32_16x16x32_bf16 v[28:31], v[64:67], v[60:63], v[28:31]
    ds_read2_b32 v[166:167], v200 offset0:2 offset1:3
    v_mfma_f32_16x16x32_bf16 v[32:35], v[68:71], v[60:63], v[32:35]
    s_waitcnt lgkmcnt(8)
    ds_read2_b32 v[168:169], v199 offset0:128 offset1:129
    v_mfma_f32_16x16x32_bf16 v[36:39], v[72:75], v[60:63], v[36:39]
    ds_read2_b32 v[170:171], v199 offset0:130 offset1:131
    v_mfma_f32_16x16x32_bf16 v[40:43], v[76:79], v[60:63], v[40:43]
    ds_read2_b32 v[172:173], v199 offset0:0 offset1:1
    v_mfma_f32_16x16x32_bf16 v[44:47], v[80:83], v[60:63], v[44:47]
    ds_read2_b32 v[174:175], v199 offset0:2 offset1:3
    ds_read_b128 v[60:63], v192 offset:1664
    v_mfma_f32_16x16x32_bf16 v[32:35], v[64:67], v[240:243], v[32:35]
    ds_read2_b32 v[176:177], v198 offset0:128 offset1:129
    v_mfma_f32_16x16x32_bf16 v[36:39], v[68:71], v[240:243], v[36:39]
    ds_read2_b32 v[178:179], v198 offset0:130 offset1:131
    v_mfma_f32_16x16x32_bf16 v[40:43], v[72:75], v[240:243], v[40:43]
    s_waitcnt lgkmcnt(8)
    ds_read2_b32 v[180:181], v198 offset0:0 offset1:1
    v_mfma_f32_16x16x32_bf16 v[44:47], v[76:79], v[240:243], v[44:47]
    ds_read2_b32 v[182:183], v198 offset0:2 offset1:3
    ds_read_b128 v[240:243], v192 offset:2176
    v_mfma_f32_16x16x32_bf16 v[36:39], v[64:67], v[244:247], v[36:39]
    ds_read2_b32 v[184:185], v197 offset0:128 offset1:129
    v_mfma_f32_16x16x32_bf16 v[40:43], v[68:71], v[244:247], v[40:43]
    ds_read2_b32 v[186:187], v197 offset0:130 offset1:131
    v_mfma_f32_16x16x32_bf16 v[44:47], v[72:75], v[244:247], v[44:47]
    ds_read2_b32 v[188:189], v197 offset0:0 offset1:1
    ds_read_b128 v[244:247], v192 offset:2688
    v_mfma_f32_16x16x32_bf16 v[40:43], v[64:67], v[248:251], v[40:43]
    s_waitcnt lgkmcnt(8)
    ds_read2_b32 v[190:191], v197 offset0:2 offset1:3
    v_mfma_f32_16x16x32_bf16 v[44:47], v[68:71], v[248:251], v[44:47]
    ds_read_b128 v[248:251], v192 offset:3200
    v_mfma_f32_16x16x32_bf16 v[44:47], v[64:67], v[252:255], v[44:47]
    ds_read_b128 v[252:255], v192 offset:3712
    v_mfma_f32_16x16x32_bf16 v[16:19], v[96:99], v[48:51], v[16:19]
    v_mfma_f32_16x16x32_bf16 v[20:23], v[100:103], v[48:51], v[20:23]
    v_mfma_f32_16x16x32_bf16 v[24:27], v[104:107], v[48:51], v[24:27]
    v_mfma_f32_16x16x32_bf16 v[28:31], v[108:111], v[48:51], v[28:31]
    v_mfma_f32_16x16x32_bf16 v[32:35], v[112:115], v[48:51], v[32:35]
    v_mfma_f32_16x16x32_bf16 v[36:39], v[116:119], v[48:51], v[36:39]
    v_mfma_f32_16x16x32_bf16 v[40:43], v[120:123], v[48:51], v[40:43]
    v_mfma_f32_16x16x32_bf16 v[44:47], v[124:127], v[48:51], v[44:47]
    ds_read_b128 v[48:51], v192 offset:64
    v_mfma_f32_16x16x32_bf16 v[20:23], v[96:99], v[52:55], v[20:23]
    v_mfma_f32_16x16x32_bf16 v[24:27], v[100:103], v[52:55], v[24:27]
    v_mfma_f32_16x16x32_bf16 v[28:31], v[104:107], v[52:55], v[28:31]
    v_mfma_f32_16x16x32_bf16 v[32:35], v[108:111], v[52:55], v[32:35]
    v_mfma_f32_16x16x32_bf16 v[36:39], v[112:115], v[52:55], v[36:39]
    v_mfma_f32_16x16x32_bf16 v[40:43], v[116:119], v[52:55], v[40:43]
    v_mfma_f32_16x16x32_bf16 v[44:47], v[120:123], v[52:55], v[44:47]
    ds_read_b128 v[52:55], v192 offset:576
    v_mfma_f32_16x16x32_bf16 v[24:27], v[96:99], v[56:59], v[24:27]
    v_mfma_f32_16x16x32_bf16 v[28:31], v[100:103], v[56:59], v[28:31]
    v_mfma_f32_16x16x32_bf16 v[32:35], v[104:107], v[56:59], v[32:35]
    v_mfma_f32_16x16x32_bf16 v[36:39], v[108:111], v[56:59], v[36:39]
    v_mfma_f32_16x16x32_bf16 v[40:43], v[112:115], v[56:59], v[40:43]
    v_mfma_f32_16x16x32_bf16 v[44:47], v[116:119], v[56:59], v[44:47]
    ds_read_b128 v[56:59], v192 offset:1088
    v_mfma_f32_16x16x32_bf16 v[28:31], v[96:99], v[60:63], v[28:31]
    v_mfma_f32_16x16x32_bf16 v[32:35], v[100:103], v[60:63], v[32:35]
    v_mfma_f32_16x16x32_bf16 v[36:39], v[104:107], v[60:63], v[36:39]
    v_mfma_f32_16x16x32_bf16 v[40:43], v[108:111], v[60:63], v[40:43]
    v_mfma_f32_16x16x32_bf16 v[44:47], v[112:115], v[60:63], v[44:47]
    ds_read_b128 v[60:63], v192 offset:1600
    s_waitcnt lgkmcnt(11)
    v_mfma_f32_16x16x32_bf16 v[32:35], v[96:99], v[240:243], v[32:35]
    v_mfma_f32_16x16x32_bf16 v[36:39], v[100:103], v[240:243], v[36:39]
    v_mfma_f32_16x16x32_bf16 v[40:43], v[104:107], v[240:243], v[40:43]
    v_mfma_f32_16x16x32_bf16 v[44:47], v[108:111], v[240:243], v[44:47]
    ds_read_b128 v[240:243], v192 offset:2112
    s_waitcnt lgkmcnt(8)
    v_mfma_f32_16x16x32_bf16 v[36:39], v[96:99], v[244:247], v[36:39]
    v_mfma_f32_16x16x32_bf16 v[40:43], v[100:103], v[244:247], v[40:43]
    v_mfma_f32_16x16x32_bf16 v[44:47], v[104:107], v[244:247], v[44:47]
    ds_read_b128 v[244:247], v192 offset:2624
    s_waitcnt lgkmcnt(7)
    v_mfma_f32_16x16x32_bf16 v[40:43], v[96:99], v[248:251], v[40:43]
    v_mfma_f32_16x16x32_bf16 v[44:47], v[100:103], v[248:251], v[44:47]
    ds_read_b128 v[248:251], v192 offset:3136
    s_waitcnt lgkmcnt(7)
    v_mfma_f32_16x16x32_bf16 v[44:47], v[96:99], v[252:255], v[44:47]
    ds_read_b128 v[252:255], v192 offset:3648
    s_waitcnt lgkmcnt(7)
    v_mfma_f32_16x16x32_bf16 v[16:19], v[128:131], v[48:51], v[16:19]
    v_mfma_f32_16x16x32_bf16 v[20:23], v[132:135], v[48:51], v[20:23]
    v_mfma_f32_16x16x32_bf16 v[24:27], v[136:139], v[48:51], v[24:27]
    v_mfma_f32_16x16x32_bf16 v[28:31], v[140:143], v[48:51], v[28:31]
    v_mfma_f32_16x16x32_bf16 v[32:35], v[144:147], v[48:51], v[32:35]
    v_mfma_f32_16x16x32_bf16 v[36:39], v[148:151], v[48:51], v[36:39]
    v_mfma_f32_16x16x32_bf16 v[40:43], v[152:155], v[48:51], v[40:43]
    v_mfma_f32_16x16x32_bf16 v[44:47], v[156:159], v[48:51], v[44:47]
    ds_read_b128 v[48:51], v192 offset:0
    s_waitcnt lgkmcnt(7)
    v_mfma_f32_16x16x32_bf16 v[20:23], v[128:131], v[52:55], v[20:23]
    v_mfma_f32_16x16x32_bf16 v[24:27], v[132:135], v[52:55], v[24:27]
    v_mfma_f32_16x16x32_bf16 v[28:31], v[136:139], v[52:55], v[28:31]
    v_mfma_f32_16x16x32_bf16 v[32:35], v[140:143], v[52:55], v[32:35]
    v_mfma_f32_16x16x32_bf16 v[36:39], v[144:147], v[52:55], v[36:39]
    v_mfma_f32_16x16x32_bf16 v[40:43], v[148:151], v[52:55], v[40:43]
    v_mfma_f32_16x16x32_bf16 v[44:47], v[152:155], v[52:55], v[44:47]
    ds_read_b128 v[52:55], v192 offset:512
    s_waitcnt lgkmcnt(7)
    v_mfma_f32_16x16x32_bf16 v[24:27], v[128:131], v[56:59], v[24:27]
    ds_read_b32 v8, v201 offset:96
    v_mfma_f32_16x16x32_bf16 v[28:31], v[132:135], v[56:59], v[28:31]
    ds_read_b128 v[4:7], v201 offset:16
    v_mfma_f32_16x16x32_bf16 v[32:35], v[136:139], v[56:59], v[32:35]
    v_mfma_f32_16x16x32_bf16 v[36:39], v[140:143], v[56:59], v[36:39]
    v_mfma_f32_16x16x32_bf16 v[40:43], v[144:147], v[56:59], v[40:43]
    v_mfma_f32_16x16x32_bf16 v[44:47], v[148:151], v[56:59], v[44:47]
    ds_read_b128 v[56:59], v192 offset:1024
    s_waitcnt lgkmcnt(9)
    v_mfma_f32_16x16x32_bf16 v[28:31], v[128:131], v[60:63], v[28:31]
    v_mfma_f32_16x16x32_bf16 v[32:35], v[132:135], v[60:63], v[32:35]
    v_mfma_f32_16x16x32_bf16 v[36:39], v[136:139], v[60:63], v[36:39]
    v_mfma_f32_16x16x32_bf16 v[40:43], v[140:143], v[60:63], v[40:43]
    s_waitcnt lgkmcnt(1)
    v_and_b32 v4, v4, v5
    v_and_b32 v6, v6, v7
    v_mfma_f32_16x16x32_bf16 v[44:47], v[144:147], v[60:63], v[44:47]
    v_and_b32 v4, v4, v6
    v_lshl_add_u32 v4, s20, 2, v4
    v_mov_b32 v9, s48
    ds_read_b128 v[60:63], v192 offset:1536
    v_mfma_f32_16x16x32_bf16 v[32:35], v[128:131], v[240:243], v[32:35]
    v_cmp_eq_u32 vcc, 2, v4
    s_and_b64 s[56:57], vcc, 1
    s_mov_b64 exec, s[56:57]
    buffer_store_dword v8, v9, s[64:67], 0 offen sc1
    s_mov_b64 exec, -1
    v_mfma_f32_16x16x32_bf16 v[36:39], v[132:135], v[240:243], v[36:39]
    v_mfma_f32_16x16x32_bf16 v[40:43], v[136:139], v[240:243], v[40:43]
    v_mfma_f32_16x16x32_bf16 v[44:47], v[140:143], v[240:243], v[44:47]
    ds_read_b128 v[240:243], v192 offset:2048
    v_mfma_f32_16x16x32_bf16 v[36:39], v[128:131], v[244:247], v[36:39]
    v_mfma_f32_16x16x32_bf16 v[40:43], v[132:135], v[244:247], v[40:43]
    v_mfma_f32_16x16x32_bf16 v[44:47], v[136:139], v[244:247], v[44:47]
    ds_read_b128 v[244:247], v192 offset:2560
    v_mfma_f32_16x16x32_bf16 v[40:43], v[128:131], v[248:251], v[40:43]
    v_mfma_f32_16x16x32_bf16 v[44:47], v[132:135], v[248:251], v[44:47]
    ds_read_b128 v[248:251], v192 offset:3072
    v_mfma_f32_16x16x32_bf16 v[44:47], v[128:131], v[252:255], v[44:47]
    ds_read_b128 v[252:255], v192 offset:3584
    s_cmp_eq_u32 s34, 0
    s_cbranch_scc1 kf_kernel_r30
kf_kernel_r31:
    v_mfma_f32_16x16x32_bf16 v[16:19], v[160:163], v[48:51], v[16:19]
    v_mov_b32 v2, 6
    v_xor_b32 v3, 4, v203
    v_mfma_f32_16x16x32_bf16 v[20:23], v[160:163], v[52:55], v[20:23]
    ds_read_b32 v88, v201 offset:96
    v_mfma_f32_16x16x32_bf16 v[20:23], v[164:167], v[48:51], v[20:23]
    ds_read_b128 v[84:87], v201 offset:16
    s_waitcnt lgkmcnt(3)
    v_mfma_f32_16x16x32_bf16 v[40:43], v[160:163], v[248:251], v[40:43]
    ds_read_b128 v[64:67], v196 offset:0
    v_mfma_f32_16x16x32_bf16 v[40:43], v[164:167], v[244:247], v[40:43]
    ds_write_b128 v193, v[16:19] offset:0
    v_mfma_f32_16x16x32_bf16 v[40:43], v[168:171], v[240:243], v[40:43]
    ds_read_b128 v[68:71], v196 offset:1088
    v_mfma_f32_16x16x32_bf16 v[40:43], v[172:175], v[60:63], v[40:43]
    ds_write_b128 v193, v[20:23] offset:1024
    v_mfma_f32_16x16x32_bf16 v[40:43], v[176:179], v[56:59], v[40:43]
    ds_read_b128 v[72:75], v196 offset:2176
    v_mfma_f32_16x16x32_bf16 v[40:43], v[180:183], v[52:55], v[40:43]
    v_mfma_f32_16x16x32_bf16 v[40:43], v[184:187], v[48:51], v[40:43]
    ds_read_b128 v[76:79], v196 offset:3264
    s_waitcnt lgkmcnt(8)
    v_mfma_f32_16x16x32_bf16 v[44:47], v[160:163], v[252:255], v[44:47]
    v_mfma_f32_16x16x32_bf16 v[44:47], v[164:167], v[248:251], v[44:47]
    v_mfma_f32_16x16x32_bf16 v[44:47], v[168:171], v[244:247], v[44:47]
    v_mfma_f32_16x16x32_bf16 v[44:47], v[172:175], v[240:243], v[44:47]
    ds_write_b128 v193, v[40:43] offset:2048
    v_mfma_f32_16x16x32_bf16 v[44:47], v[176:179], v[60:63], v[44:47]
    v_mfma_f32_16x16x32_bf16 v[44:47], v[180:183], v[56:59], v[44:47]
    v_mfma_f32_16x16x32_bf16 v[44:47], v[184:187], v[52:55], v[44:47]
    v_mfma_f32_16x16x32_bf16 v[44:47], v[188:191], v[48:51], v[44:47]
    v_mfma_f32_16x16x32_bf16 v[24:27], v[160:163], v[56:59], v[24:27]
    v_mfma_f32_16x16x32_bf16 v[24:27], v[164:167], v[52:55], v[24:27]
    v_mfma_f32_16x16x32_bf16 v[24:27], v[168:171], v[48:51], v[24:27]
    v_mfma_f32_16x16x32_bf16 v[28:31], v[160:163], v[60:63], v[28:31]
    ds_write_b128 v193, v[44:47] offset:3072
    v_mfma_f32_16x16x32_bf16 v[28:31], v[164:167], v[56:59], v[28:31]
    ds_write_b32 v203, v2
    v_mfma_f32_16x16x32_bf16 v[28:31], v[168:171], v[52:55], v[28:31]
    s_waitcnt lgkmcnt(3)
    v_and_b32 v84, v84, v85
    v_and_b32 v86, v86, v87
    v_mfma_f32_16x16x32_bf16 v[28:31], v[172:175], v[48:51], v[28:31]
    v_and_b32 v84, v84, v86
    v_readfirstlane_b32 s21, v88
    v_mfma_f32_16x16x32_bf16 v[32:35], v[160:163], v[240:243], v[32:35]
    v_mfma_f32_16x16x32_bf16 v[32:35], v[164:167], v[60:63], v[32:35]
    v_mfma_f32_16x16x32_bf16 v[32:35], v[168:171], v[56:59], v[32:35]
    v_mfma_f32_16x16x32_bf16 v[32:35], v[172:175], v[52:55], v[32:35]
    v_mfma_f32_16x16x32_bf16 v[32:35], v[176:179], v[48:51], v[32:35]
    ds_read_b32 v85, v3
    v_mfma_f32_16x16x32_bf16 v[36:39], v[160:163], v[244:247], v[36:39]
    ds_read_b128 v[96:99], v194 offset:0
    v_mfma_f32_16x16x32_bf16 v[36:39], v[164:167], v[240:243], v[36:39]
    ds_read_b128 v[100:103], v194 offset:1024
    v_mfma_f32_16x16x32_bf16 v[36:39], v[168:171], v[60:63], v[36:39]
    ds_read_b128 v[104:107], v194 offset:2048
    v_mfma_f32_16x16x32_bf16 v[36:39], v[172:175], v[56:59], v[36:39]
    ds_read_b128 v[108:111], v194 offset:3072
    v_mfma_f32_16x16x32_bf16 v[36:39], v[176:179], v[52:55], v[36:39]
    v_mfma_f32_16x16x32_bf16 v[36:39], v[180:183], v[48:51], v[36:39]
    s_waitcnt lgkmcnt(4)
    v_lshrrev_b32 v85, 1, v85
    v_and_b32 v84, v84, v85
    v_cmp_ne_u32 vcc, 2, v84
    s_cbranch_vccnz kf_kernel_yw1
kf_kernel_yk1:
    s_or_b32 s56, s56, s20
    s_cbranch_scc1 kf_kernel_nm1
    s_mov_b64 exec, 1
    v_mov_b32 v12, s48
    v_mov_b32 v13, s21
    buffer_store_dword v13, v12, s[64:67], 0 offen sc1
    s_mov_b64 exec, -1
kf_kernel_nm1:
    s_waitcnt lgkmcnt(3)
    v_pk_add_f32 v[96:97], v[96:97], v[64:65]
    v_pk_add_f32 v[98:99], v[98:99], v[66:67]
    s_waitcnt lgkmcnt(2)
    v_pk_add_f32 v[100:101], v[100:101], v[68:69]
    v_pk_add_f32 v[102:103], v[102:103], v[70:71]
    s_waitcnt lgkmcnt(1)
    v_pk_add_f32 v[104:105], v[104:105], v[72:73]
    v_pk_add_f32 v[106:107], v[106:107], v[74:75]
    s_waitcnt lgkmcnt(0)
    v_pk_add_f32 v[108:109], v[108:109], v[76:77]
    v_pk_add_f32 v[110:111], v[110:111], v[78:79]
    v_pk_add_f32 v[96:97], v[96:97], v[24:25]
    v_pk_add_f32 v[98:99], v[98:99], v[26:27]
    v_cvt_pk_bf16_f32 v112, v96, v97
    v_cvt_pk_bf16_f32 v113, v98, v99
    v_pk_add_f32 v[100:101], v[100:101], v[28:29]
    v_pk_add_f32 v[102:103], v[102:103], v[30:31]
    v_cvt_pk_bf16_f32 v114, v100, v101
    v_cvt_pk_bf16_f32 v115, v102, v103
    s_nop 1
    v_permlane16_swap_b32 v112, v114
    v_permlane16_swap_b32 v113, v115
    v_min_u32 v112, -2, v112
    buffer_store_dwordx4 v[112:115], v195, s[64:67], s47 offen sc1
    s_add_u32 s47, s47, 524288
    v_pk_add_f32 v[104:105], v[104:105], v[32:33]
    v_pk_add_f32 v[106:107], v[106:107], v[34:35]
    v_cvt_pk_bf16_f32 v116, v104, v105
    v_cvt_pk_bf16_f32 v117, v106, v107
    v_pk_add_f32 v[108:109], v[108:109], v[36:37]
    v_pk_add_f32 v[110:111], v[110:111], v[38:39]
    v_cvt_pk_bf16_f32 v118, v108, v109
    v_cvt_pk_bf16_f32 v119, v110, v111
    s_nop 1
    v_permlane16_swap_b32 v116, v118
    v_permlane16_swap_b32 v117, v119
    v_min_u32 v116, -2, v116
    buffer_store_dwordx4 v[116:119], v195, s[64:67], s47 offen sc1
    s_branch kf_kernel_yj
kf_kernel_r30:
    s_waitcnt lgkmcnt(5)
    v_mfma_f32_16x16x32_bf16 v[24:27], v[160:163], v[56:59], v[24:27]
    v_mov_b32 v2, 6
    v_xor_b32 v3, 4, v203
    v_mfma_f32_16x16x32_bf16 v[24:27], v[164:167], v[52:55], v[24:27]
    ds_read_b32 v88, v201 offset:96
    v_mfma_f32_16x16x32_bf16 v[24:27], v[168:171], v[48:51], v[24:27]
    ds_read_b128 v[84:87], v201 offset:16
    s_waitcnt lgkmcnt(6)
    v_mfma_f32_16x16x32_bf16 v[28:31], v[160:163], v[60:63], v[28:31]
    ds_read_b128 v[64:67], v196 offset:0
    v_mfma_f32_16x16x32_bf16 v[28:31], v[164:167], v[56:59], v[28:31]
    v_mfma_f32_16x16x32_bf16 v[28:31], v[168:171], v[52:55], v[28:31]
    ds_read_b128 v[68:71], v196 offset:1088
    v_mfma_f32_16x16x32_bf16 v[28:31], v[172:175], v[48:51], v[28:31]
    ds_write_b128 v193, v[24:27] offset:0
    s_waitcnt lgkmcnt(8)
    v_mfma_f32_16x16x32_bf16 v[32:35], v[160:163], v[240:243], v[32:35]
    ds_read_b128 v[72:75], v196 offset:2176
    v_mfma_f32_16x16x32_bf16 v[32:35], v[164:167], v[60:63], v[32:35]
    v_mfma_f32_16x16x32_bf16 v[32:35], v[168:171], v[56:59], v[32:35]
    ds_read_b128 v[76:79], v196 offset:3264
    v_mfma_f32_16x16x32_bf16 v[32:35], v[172:175], v[52:55], v[32:35]
    ds_write_b128 v193, v[28:31] offset:1024
    v_mfma_f32_16x16x32_bf16 v[32:35], v[176:179], v[48:51], v[32:35]
    s_waitcnt lgkmcnt(10)
    v_mfma_f32_16x16x32_bf16 v[36:39], v[160:163], v[244:247], v[36:39]
    v_mfma_f32_16x16x32_bf16 v[36:39], v[164:167], v[240:243], v[36:39]
    v_mfma_f32_16x16x32_bf16 v[36:39], v[168:171], v[60:63], v[36:39]
    v_mfma_f32_16x16x32_bf16 v[36:39], v[172:175], v[56:59], v[36:39]
    ds_write_b128 v193, v[32:35] offset:2048
    v_mfma_f32_16x16x32_bf16 v[36:39], v[176:179], v[52:55], v[36:39]
    v_mfma_f32_16x16x32_bf16 v[36:39], v[180:183], v[48:51], v[36:39]
    v_mfma_f32_16x16x32_bf16 v[16:19], v[160:163], v[48:51], v[16:19]
    v_mfma_f32_16x16x32_bf16 v[20:23], v[160:163], v[52:55], v[20:23]
    v_mfma_f32_16x16x32_bf16 v[20:23], v[164:167], v[48:51], v[20:23]
    s_waitcnt lgkmcnt(10)
    v_mfma_f32_16x16x32_bf16 v[40:43], v[160:163], v[248:251], v[40:43]
    ds_write_b128 v193, v[36:39] offset:3072
    v_mfma_f32_16x16x32_bf16 v[40:43], v[164:167], v[244:247], v[40:43]
    ds_write_b32 v203, v2
    v_mfma_f32_16x16x32_bf16 v[40:43], v[168:171], v[240:243], v[40:43]
    s_waitcnt lgkmcnt(4)
    v_and_b32 v84, v84, v85
    v_and_b32 v86, v86, v87
    v_mfma_f32_16x16x32_bf16 v[40:43], v[172:175], v[60:63], v[40:43]
    v_and_b32 v84, v84, v86
    v_readfirstlane_b32 s21, v88
    v_mfma_f32_16x16x32_bf16 v[40:43], v[176:179], v[56:59], v[40:43]
    v_mfma_f32_16x16x32_bf16 v[40:43], v[180:183], v[52:55], v[40:43]
    v_mfma_f32_16x16x32_bf16 v[40:43], v[184:187], v[48:51], v[40:43]
    v_mfma_f32_16x16x32_bf16 v[44:47], v[160:163], v[252:255], v[44:47]
    v_mfma_f32_16x16x32_bf16 v[44:47], v[164:167], v[248:251], v[44:47]
    ds_read_b32 v85, v3
    v_mfma_f32_16x16x32_bf16 v[44:47], v[168:171], v[244:247], v[44:47]
    ds_read_b128 v[96:99], v194 offset:0
    v_mfma_f32_16x16x32_bf16 v[44:47], v[172:175], v[240:243], v[44:47]
    ds_read_b128 v[100:103], v194 offset:1024
    v_mfma_f32_16x16x32_bf16 v[44:47], v[176:179], v[60:63], v[44:47]
    ds_read_b128 v[104:107], v194 offset:2048
    v_mfma_f32_16x16x32_bf16 v[44:47], v[180:183], v[56:59], v[44:47]
    ds_read_b128 v[108:111], v194 offset:3072
    v_mfma_f32_16x16x32_bf16 v[44:47], v[184:187], v[52:55], v[44:47]
    v_mfma_f32_16x16x32_bf16 v[44:47], v[188:191], v[48:51], v[44:47]
    s_waitcnt lgkmcnt(4)
    v_lshrrev_b32 v85, 1, v85
    v_and_b32 v84, v84, v85
    v_cmp_ne_u32 vcc, 2, v84
    s_cbranch_vccnz kf_kernel_yw0
kf_kernel_yk0:
    s_or_b32 s56, s56, s20
    s_cbranch_scc1 kf_kernel_nm0
    s_mov_b64 exec, 1
    v_mov_b32 v12, s48
    v_mov_b32 v13, s21
    buffer_store_dword v13, v12, s[64:67], 0 offen sc1
    s_mov_b64 exec, -1
kf_kernel_nm0:
    s_waitcnt lgkmcnt(3)
    v_pk_add_f32 v[96:97], v[96:97], v[64:65]
    v_pk_add_f32 v[98:99], v[98:99], v[66:67]
    s_waitcnt lgkmcnt(2)
    v_pk_add_f32 v[100:101], v[100:101], v[68:69]
    v_pk_add_f32 v[102:103], v[102:103], v[70:71]
    s_waitcnt lgkmcnt(1)
    v_pk_add_f32 v[104:105], v[104:105], v[72:73]
    v_pk_add_f32 v[106:107], v[106:107], v[74:75]
    s_waitcnt lgkmcnt(0)
    v_pk_add_f32 v[108:109], v[108:109], v[76:77]
    v_pk_add_f32 v[110:111], v[110:111], v[78:79]
    v_pk_add_f32 v[96:97], v[96:97], v[16:17]
    v_pk_add_f32 v[98:99], v[98:99], v[18:19]
    v_cvt_pk_bf16_f32 v112, v96, v97
    v_cvt_pk_bf16_f32 v113, v98, v99
    v_pk_add_f32 v[100:101], v[100:101], v[20:21]
    v_pk_add_f32 v[102:103], v[102:103], v[22:23]
    v_cvt_pk_bf16_f32 v114, v100, v101
    v_cvt_pk_bf16_f32 v115, v102, v103
    s_nop 1
    v_permlane16_swap_b32 v112, v114
    v_permlane16_swap_b32 v113, v115
    v_min_u32 v112, -2, v112
    buffer_store_dwordx4 v[112:115], v195, s[64:67], s47 offen sc1
    s_add_u32 s47, s47, 1572864
    v_pk_add_f32 v[104:105], v[104:105], v[40:41]
    v_pk_add_f32 v[106:107], v[106:107], v[42:43]
    v_cvt_pk_bf16_f32 v116, v104, v105
    v_cvt_pk_bf16_f32 v117, v106, v107
    v_pk_add_f32 v[108:109], v[108:109], v[44:45]
    v_pk_add_f32 v[110:111], v[110:111], v[46:47]
    v_cvt_pk_bf16_f32 v118, v108, v109
    v_cvt_pk_bf16_f32 v119, v110, v111
    s_nop 1
    v_permlane16_swap_b32 v116, v118
    v_permlane16_swap_b32 v117, v119
    v_min_u32 v116, -2, v116
    buffer_store_dwordx4 v[116:119], v195, s[64:67], s47 offen sc1
kf_kernel_yj:
    v_mov_b32 v63, 1
    s_mov_b64 exec, 1
    ds_add_u32 v201, v63 offset:80
    s_mov_b64 exec, -1
    s_cmp_ge_u32 s22, 224
    s_cbranch_scc1 kf_kernel_ncs2
    s_waitcnt vmcnt(2)
    v_and_b32 v14, 7, v1
    v_lshlrev_b32 v13, 6, v14
    v_lshrrev_b32 v14, 4, v1
    v_lshl_add_u32 v13, v14, 4, v13
    v_lshlrev_b32 v64, 16, v208
    v_and_b32 v65, 0xffff0000, v208
    v_lshlrev_b32 v66, 16, v209
    v_and_b32 v67, 0xffff0000, v209
    v_lshlrev_b32 v68, 16, v210
    v_and_b32 v69, 0xffff0000, v210
    v_lshlrev_b32 v70, 16, v211
    v_and_b32 v71, 0xffff0000, v211
    v_lshlrev_b32 v72, 16, v212
    v_and_b32 v73, 0xffff0000, v212
    v_lshlrev_b32 v74, 16, v213
    v_and_b32 v75, 0xffff0000, v213
    v_lshlrev_b32 v76, 16, v214
    v_and_b32 v77, 0xffff0000, v214
    v_lshlrev_b32 v78, 16, v215
    v_and_b32 v79, 0xffff0000, v215
    v_pk_add_f32 v[64:65], v[64:65], v[72:73]
    v_pk_add_f32 v[66:67], v[66:67], v[74:75]
    v_pk_add_f32 v[68:69], v[68:69], v[76:77]
    v_pk_add_f32 v[70:71], v[70:71], v[78:79]
    v_lshlrev_b32 v72, 16, v216
    v_and_b32 v73, 0xffff0000, v216
    v_lshlrev_b32 v74, 16, v217
    v_and_b32 v75, 0xffff0000, v217
    v_lshlrev_b32 v76, 16, v218
    v_and_b32 v77, 0xffff0000, v218
    v_lshlrev_b32 v78, 16, v219
    v_and_b32 v79, 0xffff0000, v219
    v_pk_add_f32 v[64:65], v[64:65], v[72:73]
    v_pk_add_f32 v[66:67], v[66:67], v[74:75]
    v_pk_add_f32 v[68:69], v[68:69], v[76:77]
    v_pk_add_f32 v[70:71], v[70:71], v[78:79]
    v_lshlrev_b32 v72, 16, v220
    v_and_b32 v73, 0xffff0000, v220
    v_lshlrev_b32 v74, 16, v221
    v_and_b32 v75, 0xffff0000, v221
    v_lshlrev_b32 v76, 16, v222
    v_and_b32 v77, 0xffff0000, v222
    v_lshlrev_b32 v78, 16, v223
    v_and_b32 v79, 0xffff0000, v223
    v_pk_add_f32 v[64:65], v[64:65], v[72:73]
    v_pk_add_f32 v[66:67], v[66:67], v[74:75]
    v_pk_add_f32 v[68:69], v[68:69], v[76:77]
    v_pk_add_f32 v[70:71], v[70:71], v[78:79]
    v_lshlrev_b32 v72, 16, v224
    v_and_b32 v73, 0xffff0000, v224
    v_lshlrev_b32 v74, 16, v225
    v_and_b32 v75, 0xffff0000, v225
    v_lshlrev_b32 v76, 16, v226
    v_and_b32 v77, 0xffff0000, v226
    v_lshlrev_b32 v78, 16, v227
    v_and_b32 v79, 0xffff0000, v227
    v_pk_add_f32 v[64:65], v[64:65], v[72:73]
    v_pk_add_f32 v[66:67], v[66:67], v[74:75]
    v_pk_add_f32 v[68:69], v[68:69], v[76:77]
    v_pk_add_f32 v[70:71], v[70:71], v[78:79]
    v_lshlrev_b32 v72, 16, v228
    v_and_b32 v73, 0xffff0000, v228
    v_lshlrev_b32 v74, 16, v229
    v_and_b32 v75, 0xffff0000, v229
    v_lshlrev_b32 v76, 16, v230
    v_and_b32 v77, 0xffff0000, v230
    v_lshlrev_b32 v78, 16, v231
    v_and_b32 v79, 0xffff0000, v231
    v_pk_add_f32 v[64:65], v[64:65], v[72:73]
    v_pk_add_f32 v[66:67], v[66:67], v[74:75]
    v_pk_add_f32 v[68:69], v[68:69], v[76:77]
    v_pk_add_f32 v[70:71], v[70:71], v[78:79]
    v_lshlrev_b32 v72, 16, v232
    v_and_b32 v73, 0xffff0000, v232
    v_lshlrev_b32 v74, 16, v233
    v_and_b32 v75, 0xffff0000, v233
    v_lshlrev_b32 v76, 16, v234
    v_and_b32 v77, 0xffff0000, v234
    v_lshlrev_b32 v78, 16, v235
    v_and_b32 v79, 0xffff0000, v235
    v_pk_add_f32 v[64:65], v[64:65], v[72:73]
    v_pk_add_f32 v[66:67], v[66:67], v[74:75]
    v_pk_add_f32 v[68:69], v[68:69], v[76:77]
    v_pk_add_f32 v[70:71], v[70:71], v[78:79]
    v_lshlrev_b32 v72, 16, v236
    v_and_b32 v73, 0xffff0000, v236
    v_lshlrev_b32 v74, 16, v237
    v_and_b32 v75, 0xffff0000, v237
    v_lshlrev_b32 v76, 16, v238
    v_and_b32 v77, 0xffff0000, v238
    v_lshlrev_b32 v78, 16, v239
    v_and_b32 v79, 0xffff0000, v239
    v_pk_add_f32 v[64:65], v[64:65], v[72:73]
    v_pk_add_f32 v[66:67], v[66:67], v[74:75]
    v_pk_add_f32 v[68:69], v[68:69], v[76:77]
    v_pk_add_f32 v[70:71], v[70:71], v[78:79]
    s_nop 1
    v_permlane32_swap_b32 v64, v68
    v_permlane32_swap_b32 v65, v69
    v_permlane32_swap_b32 v66, v70
    v_permlane32_swap_b32 v67, v71
    v_pk_add_f32 v[64:65], v[64:65], v[68:69]
    v_pk_add_f32 v[66:67], v[66:67], v[70:71]
    s_nop 1
    v_permlane16_swap_b32 v64, v66
    v_permlane16_swap_b32 v65, v67
    v_pk_add_f32 v[64:65], v[64:65], v[66:67]
    v_mov_b32 v85, s21
    v_mov_b32 v87, s21
    v_add_f32_dpp v84, v64, v64 row_ror:8 row_mask:0xf bank_mask:0xf
    v_add_f32_dpp v86, v65, v65 row_ror:8 row_mask:0xf bank_mask:0xf
    s_mov_b32 exec_lo, 0x00ff00ff
    s_mov_b32 exec_hi, 0x00ff00ff
    buffer_store_dwordx4 v[84:87], v13, s[64:67], s23 offen sc1
    s_mov_b64 exec, -1
kf_kernel_ncs2:
    v_add_u32 v11, 32, v203
    v_mov_b32 v59, s21
    v_lshrrev_b32 v2, 5, v1
    v_bfe_u32 v3, v1, 2, 2
    v_bfe_u32 v14, v1, 4, 1
    v_lshlrev_b32 v15, 5, v14
    v_and_b32 v14, 3, v1
    v_lshl_add_u32 v15, v14, 3, v15
    v_mul_u32_u24 v8, 1088, v3
    v_lshl_add_u32 v8, v2, 8, v8
    v_add_u32 v8, v8, v15
    s_lshl_b32 s35, s20, 6
    s_add_u32 s35, s35, 98304
    v_add_u32 v8, s35, v8
    v_lshl_add_u32 v14, v2, 9, v15
    v_lshl_add_u32 v14, v3, 7, v14
    v_lshrrev_b32 v13, 1, v3
    v_lshl_add_u32 v4, v13, 6, v14
    v_add_u32 v6, 65536, v4
    v_xor_b32 v5, 64, v4
    v_add_u32 v7, 65536, v5
    v_lshrrev_b32 v13, 4, v1
    v_lshrrev_b32 v14, 2, v1
    v_xor_b32 v13, v13, v14
    v_and_b32 v13, 1, v13
    v_cmp_eq_u32 vcc, 0, v13
    v_mov_b32 v14, 0x3f803f80
    s_lshl_b32 s33, s6, 2
    s_add_u32 s33, s33, s20
    v_cndmask_b32 v16, 0, v14, vcc
    v_cndmask_b32 v17, 0, v14, vcc
    v_cndmask_b32 v18, 0, v14, vcc
    v_cndmask_b32 v19, 0, v14, vcc
    v_and_b32 v13, 7, v1
    v_lshlrev_b32 v13, 2, v13
    v_lshrrev_b32 v13, v13, v59
    v_and_b32 v14, 1, v13
    v_lshlrev_b32 v14, 15, v14
    v_and_b32 v112, 2, v13
    v_lshl_or_b32 v112, v112, 30, v14
    v_and_b32 v14, 4, v13
    v_lshlrev_b32 v14, 13, v14
    v_and_b32 v113, 8, v13
    v_lshl_or_b32 v113, v113, 28, v14
    v_lshlrev_b32 v9, 4, v1
    s_mul_i32 s36, s33, 114688
    s_lshl_b32 s35, s7, 13
    s_add_u32 s36, s36, s35
    s_add_u32 s36, s36, 0xa00000
    s_add_u32 s37, s36, 4096
    v_lshlrev_b32 v10, 4, v2
    v_add_u32 v10, 159232, v10
    s_lshl_b32 s38, s7, 9
    s_lshl_b32 s35, s20, 7
    s_add_u32 s38, s38, s35
    s_lshl_b32 s38, s38, 1
    s_add_u32 s38, s38, 0x1120000
    v_and_b32 v3, 31, v1
    v_lshlrev_b32 v3, 2, v3
    v_mul_u32_u24 v13, 57344, v2
    v_lshl_add_u32 v13, v3, 1, v13
    s_add_u32 s39, s38, 14336
    s_add_u32 s40, s38, 28672
    s_add_u32 s41, s38, 43008
    s_add_u32 s35, s35, 159232
    v_add_u32 v14, s35, v3
    v_add_u32 v125, 16, v11
    v_mov_b32 v126, 161280
    s_and_b32 s60, s20, 1
    s_lshr_b32 s61, s20, 1
    v_bfe_u32 v62, v1, 2, 2
    v_lshl_add_u32 v60, v2, 9, v15
    v_lshl_add_u32 v60, v62, 7, v60
    s_lshl_b32 s35, s61, 12
    s_lshl_b32 s42, s60, 6
    s_add_u32 s35, s35, s42
    s_add_u32 s35, s35, 150528
    v_add_u32 v123, s35, v60
    v_lshrrev_b32 v62, 1, v62
    v_xor_b32 v62, s61, v62
    v_lshl_add_u32 v60, v62, 6, v60
    v_xor_b32 v61, 64, v60
    s_lshl_b32 s53, s20, 13
    s_add_u32 s50, s53, 32768
    v_add_u32 v114, s50, v60
    v_add_u32 v115, s50, v61
    s_add_u32 s51, s53, 115712
    v_add_u32 v116, s51, v60
    v_add_u32 v117, s51, v61
    s_add_u32 s52, s53, 65536
    v_add_u32 v118, s52, v60
    v_add_u32 v119, s52, v61
    v_add_u32 v120, s53, v60
    v_add_u32 v121, s53, v61
    s_xor_b32 s35, s20, 1
    s_lshl_b32 s35, s35, 13
    s_add_u32 s55, s35, 0
    s_xor_b32 s35, s20, 2
    s_lshl_b32 s35, s35, 13
    s_add_u32 s56, s35, 4096
    s_xor_b32 s35, s20, 3
    s_lshl_b32 s35, s35, 13
    s_add_u32 s57, s35, 32768
    s_lshl_b32 s35, s8, 1
    s_add_u32 s42, s35, s60
    s_mul_i32 s45, s42, 114688
    s_xor_b32 s42, s42, 1
    s_mul_i32 s46, s42, 114688
    s_mul_i32 s42, s20, 28672
    s_add_u32 s42, s42, 0xa00000
    s_add_u32 s45, s45, s42
    s_add_u32 s46, s46, s42
    s_cmp_eq_u32 s60, 0
    s_cselect_b32 s42, 24576, 0
    s_add_u32 s58, s45, s42
    s_add_u32 s59, s46, s42
    s_min_u32 s48, s45, s46
    s_lshl_b32 s42, s60, 12
    s_add_u32 s45, s45, s42
    s_add_u32 s46, s46, s42
    s_lshl_b32 s35, s8, 6
    s_lshl_b32 s42, s60, 5
    s_add_u32 s35, s35, s42
    v_and_b32 v60, 31, v1
    s_lshl_b32 s42, s60, 7
    s_add_u32 s42, s42, 159232
    v_lshl_add_u32 v124, v60, 2, s42
    v_lshlrev_b32 v122, 10, v60
    v_lshl_add_u32 v122, v2, 4, v122
    s_lshl_b32 s49, s35, 10
    s_lshl_b32 s42, s9, 7
    s_add_u32 s49, s49, s42
    s_lshl_b32 s42, s61, 6
    s_add_u32 s49, s49, s42
    s_mov_b32 s68, s18
    s_and_b32 s69, s19, 0xffff
    s_mov_b32 s70, 0x200000
    s_mov_b32 s71, 0x20000
    s_mov_b32 s47, 0
    s_cmp_ge_u32 s2, 224
    s_cbranch_scc1 kf_kernel_idle
    s_mov_b32 s63, 0
kf_kernel_rpt:
    v_add_u32 v127, 65536, v9
    s_lshl_b32 s35, s20, 11
    v_add_u32 v128, s35, v4
    v_add_u32 v129, s35, v5
    v_add_u32 v130, s35, v6
    v_add_u32 v131, s35, v7
    v_add_u32 v132, s35, v9
    v_add_u32 v133, s35, v127
    s_mov_b32 s35, 0
kf_kernel_pw1:
    ds_read_b128 v[60:63], v126 offset:48
    s_add_u32 s35, s35, 1
    s_cmp_gt_u32 s35, 65536
    s_cbranch_scc1 kf_kernel_pw1o
    s_waitcnt lgkmcnt(0)
    v_min_u32 v60, v60, v61
    v_min3_u32 v60, v60, v62, v63
    v_cmp_gt_u32 vcc, 1, v60
    s_cbranch_vccnz kf_kernel_pw1
kf_kernel_pw1o:
    ds_read_b64_tr_b16 v[136:137], v128 offset:0
    ds_read_b64_tr_b16 v[138:139], v128 offset:1024
    ds_read_b64_tr_b16 v[140:141], v129 offset:0
    ds_read_b64_tr_b16 v[142:143], v129 offset:1024
    ds_read_b64_tr_b16 v[144:145], v128 offset:8192
    ds_read_b64_tr_b16 v[146:147], v128 offset:9216
    ds_read_b64_tr_b16 v[148:149], v129 offset:8192
    ds_read_b64_tr_b16 v[150:151], v129 offset:9216
    ds_read_b64_tr_b16 v[152:153], v128 offset:16384
    ds_read_b64_tr_b16 v[154:155], v128 offset:17408
    ds_read_b64_tr_b16 v[156:157], v129 offset:16384
    ds_read_b64_tr_b16 v[158:159], v129 offset:17408
    s_waitcnt lgkmcnt(8)
    ds_write_b128 v132, v[136:139] offset:0
    ds_write_b128 v132, v[140:143] offset:1024
    ds_read_b64_tr_b16 v[136:137], v128 offset:24576
    ds_read_b64_tr_b16 v[138:139], v128 offset:25600
    ds_read_b64_tr_b16 v[140:141], v129 offset:24576
    ds_read_b64_tr_b16 v[142:143], v129 offset:25600
    s_waitcnt lgkmcnt(10)
    ds_write_b128 v132, v[144:147] offset:8192
    ds_write_b128 v132, v[148:151] offset:9216
    ds_read_b64_tr_b16 v[144:145], v128 offset:32768
    ds_read_b64_tr_b16 v[146:147], v128 offset:33792
    ds_read_b64_tr_b16 v[148:149], v129 offset:32768
    s_waitcnt lgkmcnt(14)
    ds_read_b64_tr_b16 v[150:151], v129 offset:33792
    s_waitcnt lgkmcnt(12)
    ds_write_b128 v132, v[152:155] offset:16384
    ds_write_b128 v132, v[156:159] offset:17408
    ds_read_b64_tr_b16 v[152:153], v128 offset:40960
    s_waitcnt lgkmcnt(14)
    ds_read_b64_tr_b16 v[154:155], v128 offset:41984
    s_waitcnt lgkmcnt(14)
    ds_read_b64_tr_b16 v[156:157], v129 offset:40960
    s_waitcnt lgkmcnt(14)
    ds_read_b64_tr_b16 v[158:159], v129 offset:41984
    s_waitcnt lgkmcnt(12)
    ds_write_b128 v132, v[136:139] offset:24576
    ds_write_b128 v132, v[140:143] offset:25600
    ds_read_b64_tr_b16 v[136:137], v128 offset:49152
    s_waitcnt lgkmcnt(14)
    ds_read_b64_tr_b16 v[138:139], v128 offset:50176
    s_waitcnt lgkmcnt(14)
    ds_read_b64_tr_b16 v[140:141], v129 offset:49152
    s_waitcnt lgkmcnt(14)
    ds_read_b64_tr_b16 v[142:143], v129 offset:50176
    s_waitcnt lgkmcnt(12)
    ds_write_b128 v132, v[144:147] offset:32768
    ds_write_b128 v132, v[148:151] offset:33792
    ds_read_b64_tr_b16 v[144:145], v128 offset:57344
    s_waitcnt lgkmcnt(14)
    ds_read_b64_tr_b16 v[146:147], v128 offset:58368
    s_waitcnt lgkmcnt(14)
    ds_read_b64_tr_b16 v[148:149], v129 offset:57344
    s_waitcnt lgkmcnt(14)
    ds_read_b64_tr_b16 v[150:151], v129 offset:58368
    s_waitcnt lgkmcnt(12)
    ds_write_b128 v132, v[152:155] offset:40960
    ds_write_b128 v132, v[156:159] offset:41984
    ds_read_b64_tr_b16 v[152:153], v130 offset:0
    s_waitcnt lgkmcnt(14)
    ds_read_b64_tr_b16 v[154:155], v130 offset:1024
    s_waitcnt lgkmcnt(14)
    ds_read_b64_tr_b16 v[156:157], v131 offset:0
    s_waitcnt lgkmcnt(14)
    ds_read_b64_tr_b16 v[158:159], v131 offset:1024
    s_waitcnt lgkmcnt(12)
    ds_write_b128 v132, v[136:139] offset:49152
    ds_write_b128 v132, v[140:143] offset:50176
    ds_read_b64_tr_b16 v[136:137], v130 offset:8192
    s_waitcnt lgkmcnt(14)
    ds_read_b64_tr_b16 v[138:139], v130 offset:9216
    s_waitcnt lgkmcnt(14)
    ds_read_b64_tr_b16 v[140:141], v131 offset:8192
    s_waitcnt lgkmcnt(14)
    ds_read_b64_tr_b16 v[142:143], v131 offset:9216
    s_waitcnt lgkmcnt(12)
    ds_write_b128 v132, v[144:147] offset:57344
    ds_write_b128 v132, v[148:151] offset:58368
    ds_read_b64_tr_b16 v[144:145], v130 offset:16384
    s_waitcnt lgkmcnt(14)
    ds_read_b64_tr_b16 v[146:147], v130 offset:17408
    s_waitcnt lgkmcnt(14)
    ds_read_b64_tr_b16 v[148:149], v131 offset:16384
    s_waitcnt lgkmcnt(14)
    ds_read_b64_tr_b16 v[150:151], v131 offset:17408
    s_waitcnt lgkmcnt(12)
    ds_write_b128 v133, v[152:155] offset:0
    ds_write_b128 v133, v[156:159] offset:1024
    ds_read_b64_tr_b16 v[152:153], v130 offset:24576
    s_waitcnt lgkmcnt(14)
    ds_read_b64_tr_b16 v[154:155], v130 offset:25600
    s_waitcnt lgkmcnt(14)
    ds_read_b64_tr_b16 v[156:157], v131 offset:24576
    s_waitcnt lgkmcnt(14)
    ds_read_b64_tr_b16 v[158:159], v131 offset:25600
    s_waitcnt lgkmcnt(12)
    ds_write_b128 v133, v[136:139] offset:8192
    ds_write_b128 v133, v[140:143] offset:9216
    s_waitcnt lgkmcnt(8)
    ds_write_b128 v133, v[144:147] offset:16384
    ds_write_b128 v133, v[148:151] offset:17408
    s_waitcnt lgkmcnt(4)
    ds_write_b128 v133, v[152:155] offset:24576
    ds_write_b128 v133, v[156:159] offset:25600
    s_waitcnt lgkmcnt(0)
    s_mov_b64 exec, 0
    s_branch kf_kernel_de_m2u0
kf_kernel_dr:
    s_mov_b64 exec, -1
    s_waitcnt vmcnt(0) lgkmcnt(0)
    s_barrier
    ds_read_b64_tr_b16 v[128:129], v8 offset:0
    ds_read_b64_tr_b16 v[130:131], v8 offset:512
    ds_read_b128 v[24:27], v9 offset:0
    ds_read_b128 v[28:31], v9 offset:1024
    ds_read_b64_tr_b16 v[132:133], v8 offset:4352
    ds_read_b64_tr_b16 v[134:135], v8 offset:4864
    ds_read_b128 v[32:35], v9 offset:2048
    ds_read_b128 v[36:39], v9 offset:3072
    buffer_load_dwordx2 v[40:41], v13, s[64:67], s38 offen sc1
    buffer_load_dwordx2 v[42:43], v13, s[64:67], s39 offen sc1
    buffer_load_dwordx2 v[44:45], v13, s[64:67], s40 offen sc1
    buffer_load_dwordx2 v[46:47], v13, s[64:67], s41 offen sc1
    s_waitcnt lgkmcnt(2)
    s_barrier
    v_mfma_f32_32x32x16_bf16 v[64:79], v[24:27], v[128:131], 0
    ds_read_b64_tr_b16 v[136:137], v8 offset:8704
    ds_read_b64_tr_b16 v[138:139], v8 offset:9216
    ds_read_b128 v[24:27], v9 offset:4096
    v_mfma_f32_32x32x16_bf16 v[80:95], v[28:31], v[128:131], 0
    ds_read_b128 v[28:31], v9 offset:5120
    v_mfma_f32_16x16x32_bf16 v[20:23], v[16:19], v[128:131], 0
    s_waitcnt lgkmcnt(5)
    v_mfma_f32_32x32x16_bf16 v[64:79], v[32:35], v[132:135], v[64:79]
    ds_read_b64_tr_b16 v[140:141], v8 offset:13056
    ds_read_b64_tr_b16 v[142:143], v8 offset:13568
    ds_read_b128 v[32:35], v9 offset:6144
    s_waitcnt lgkmcnt(7)
    v_mfma_f32_32x32x16_bf16 v[80:95], v[36:39], v[132:135], v[80:95]
    ds_read_b128 v[36:39], v9 offset:7168
    v_mfma_f32_16x16x32_bf16 v[20:23], v[16:19], v[132:135], v[20:23]
    s_waitcnt lgkmcnt(2)
    s_barrier
    v_mfma_f32_32x32x16_bf16 v[64:79], v[24:27], v[136:139], v[64:79]
    ds_read_b64_tr_b16 v[144:145], v8 offset:17408
    ds_read_b64_tr_b16 v[146:147], v8 offset:17920
    ds_read_b128 v[24:27], v9 offset:8192
    v_mfma_f32_32x32x16_bf16 v[80:95], v[28:31], v[136:139], v[80:95]
    ds_read_b128 v[28:31], v9 offset:9216
    v_mfma_f32_16x16x32_bf16 v[20:23], v[16:19], v[136:139], v[20:23]
    s_waitcnt lgkmcnt(5)
    v_mfma_f32_32x32x16_bf16 v[64:79], v[32:35], v[140:143], v[64:79]
    ds_read_b64_tr_b16 v[148:149], v8 offset:21760
    ds_read_b64_tr_b16 v[150:151], v8 offset:22272
    ds_read_b128 v[32:35], v9 offset:10240
    s_waitcnt lgkmcnt(7)
    v_mfma_f32_32x32x16_bf16 v[80:95], v[36:39], v[140:143], v[80:95]
    ds_read_b128 v[36:39], v9 offset:11264
    v_mfma_f32_16x16x32_bf16 v[20:23], v[16:19], v[140:143], v[20:23]
    s_waitcnt lgkmcnt(2)
    s_barrier
    v_mfma_f32_32x32x16_bf16 v[64:79], v[24:27], v[144:147], v[64:79]
    ds_read_b64_tr_b16 v[152:153], v8 offset:26112
    ds_read_b64_tr_b16 v[154:155], v8 offset:26624
    ds_read_b128 v[24:27], v9 offset:12288
    v_mfma_f32_32x32x16_bf16 v[80:95], v[28:31], v[144:147], v[80:95]
    ds_read_b128 v[28:31], v9 offset:13312
    v_mfma_f32_16x16x32_bf16 v[20:23], v[16:19], v[144:147], v[20:23]
    s_waitcnt lgkmcnt(5)
    v_mfma_f32_32x32x16_bf16 v[64:79], v[32:35], v[148:151], v[64:79]
    ds_read_b64_tr_b16 v[156:157], v8 offset:30464
    ds_read_b64_tr_b16 v[158:159], v8 offset:30976
    ds_read_b128 v[32:35], v9 offset:14336
    s_waitcnt lgkmcnt(7)
    v_mfma_f32_32x32x16_bf16 v[80:95], v[36:39], v[148:151], v[80:95]
    ds_read_b128 v[36:39], v9 offset:15360
    v_mfma_f32_16x16x32_bf16 v[20:23], v[16:19], v[148:151], v[20:23]
    s_waitcnt lgkmcnt(2)
    s_barrier
    v_mfma_f32_32x32x16_bf16 v[64:79], v[24:27], v[152:155], v[64:79]
    ds_read_b64_tr_b16 v[160:161], v8 offset:34816
    ds_read_b64_tr_b16 v[162:163], v8 offset:35328
    ds_read_b128 v[24:27], v9 offset:16384
    v_mfma_f32_32x32x16_bf16 v[80:95], v[28:31], v[152:155], v[80:95]
    ds_read_b128 v[28:31], v9 offset:17408
    v_mfma_f32_16x16x32_bf16 v[20:23], v[16:19], v[152:155], v[20:23]
    s_waitcnt lgkmcnt(5)
    v_mfma_f32_32x32x16_bf16 v[64:79], v[32:35], v[156:159], v[64:79]
    ds_read_b64_tr_b16 v[164:165], v8 offset:39168
    ds_read_b64_tr_b16 v[166:167], v8 offset:39680
    ds_read_b128 v[32:35], v9 offset:18432
    s_waitcnt lgkmcnt(7)
    v_mfma_f32_32x32x16_bf16 v[80:95], v[36:39], v[156:159], v[80:95]
    ds_read_b128 v[36:39], v9 offset:19456
    v_mfma_f32_16x16x32_bf16 v[20:23], v[16:19], v[156:159], v[20:23]
    s_waitcnt lgkmcnt(2)
    s_barrier
    v_mfma_f32_32x32x16_bf16 v[64:79], v[24:27], v[160:163], v[64:79]
    ds_read_b64_tr_b16 v[168:169], v8 offset:43520
    ds_read_b64_tr_b16 v[170:171], v8 offset:44032
    ds_read_b128 v[24:27], v9 offset:20480
    v_mfma_f32_32x32x16_bf16 v[80:95], v[28:31], v[160:163], v[80:95]
    ds_read_b128 v[28:31], v9 offset:21504
    v_mfma_f32_16x16x32_bf16 v[20:23], v[16:19], v[160:163], v[20:23]
    s_waitcnt lgkmcnt(5)
    v_mfma_f32_32x32x16_bf16 v[64:79], v[32:35], v[164:167], v[64:79]
    ds_read_b64_tr_b16 v[172:173], v8 offset:47872
    ds_read_b64_tr_b16 v[174:175], v8 offset:48384
    ds_read_b128 v[32:35], v9 offset:22528
    s_waitcnt lgkmcnt(7)
    v_mfma_f32_32x32x16_bf16 v[80:95], v[36:39], v[164:167], v[80:95]
    ds_read_b128 v[36:39], v9 offset:23552
    v_mfma_f32_16x16x32_bf16 v[20:23], v[16:19], v[164:167], v[20:23]
    s_waitcnt lgkmcnt(2)
    s_barrier
    v_mfma_f32_32x32x16_bf16 v[64:79], v[24:27], v[168:171], v[64:79]
    ds_read_b64_tr_b16 v[176:177], v8 offset:52224
    ds_read_b64_tr_b16 v[178:179], v8 offset:52736
    ds_read_b128 v[24:27], v9 offset:24576
    v_mfma_f32_32x32x16_bf16 v[80:95], v[28:31], v[168:171], v[80:95]
    ds_read_b128 v[28:31], v9 offset:25600
    v_mfma_f32_16x16x32_bf16 v[20:23], v[16:19], v[168:171], v[20:23]
    s_waitcnt lgkmcnt(5)
    v_mfma_f32_32x32x16_bf16 v[64:79], v[32:35], v[172:175], v[64:79]
    ds_read_b64_tr_b16 v[180:181], v8 offset:56576
    ds_read_b64_tr_b16 v[182:183], v8 offset:57088
    ds_read_b128 v[32:35], v9 offset:26624
    s_waitcnt lgkmcnt(7)
    v_mfma_f32_32x32x16_bf16 v[80:95], v[36:39], v[172:175], v[80:95]
    ds_read_b128 v[36:39], v9 offset:27648
    v_mfma_f32_16x16x32_bf16 v[20:23], v[16:19], v[172:175], v[20:23]
    s_waitcnt vmcnt(0)
    v_xor_b32 v41, s21, v41
    v_xor_b32 v43, s21, v43
    v_xor_b32 v45, s21, v45
    v_xor_b32 v47, s21, v47
    s_waitcnt lgkmcnt(2)
    s_barrier
    v_mfma_f32_32x32x16_bf16 v[64:79], v[24:27], v[176:179], v[64:79]
    ds_read_b64_tr_b16 v[184:185], v8 offset:0
    ds_read_b64_tr_b16 v[186:187], v8 offset:512
    ds_read_b128 v[24:27], v9 offset:28672
    v_mfma_f32_32x32x16_bf16 v[80:95], v[28:31], v[176:179], v[80:95]
    ds_read_b128 v[28:31], v9 offset:29696
    v_mfma_f32_16x16x32_bf16 v[20:23], v[16:19], v[176:179], v[20:23]
    v_or3_b32 v41, v41, v43, v45
    v_or_b32 v41, v41, v47
    v_cmp_ne_u32 vcc, 0, v41
    s_mov_b32 s54, 0
    s_cbranch_vccnz kf_kernel_csr
kf_kernel_csok:
    v_add_f32 v40, v40, v42
    v_add_f32 v42, v44, v46
    s_waitcnt lgkmcnt(5)
    v_mfma_f32_32x32x16_bf16 v[64:79], v[32:35], v[180:183], v[64:79]
    ds_read_b64_tr_b16 v[188:189], v8 offset:4352
    ds_read_b64_tr_b16 v[190:191], v8 offset:4864
    ds_read_b128 v[32:35], v9 offset:30720
    s_waitcnt lgkmcnt(7)
    v_mfma_f32_32x32x16_bf16 v[80:95], v[36:39], v[180:183], v[80:95]
    ds_read_b128 v[36:39], v9 offset:31744
    v_mfma_f32_16x16x32_bf16 v[20:23], v[16:19], v[180:183], v[20:23]
    v_add_f32 v40, v40, v42
    v_mov_b32 v41, v40
    s_waitcnt lgkmcnt(2)
    s_barrier
    v_mfma_f32_32x32x16_bf16 v[64:79], v[24:27], v[184:187], v[64:79]
    ds_read_b64_tr_b16 v[192:193], v8 offset:8704
    ds_read_b64_tr_b16 v[194:195], v8 offset:9216
    ds_read_b128 v[24:27], v9 offset:32768
    v_mfma_f32_32x32x16_bf16 v[80:95], v[28:31], v[184:187], v[80:95]
    ds_read_b128 v[28:31], v9 offset:33792
    v_mfma_f32_16x16x32_bf16 v[20:23], v[16:19], v[184:187], v[20:23]
    v_permlane32_swap_b32 v40, v41
    s_waitcnt lgkmcnt(5)
    v_mfma_f32_32x32x16_bf16 v[64:79], v[32:35], v[188:191], v[64:79]
    ds_read_b64_tr_b16 v[196:197], v8 offset:13056
    ds_read_b64_tr_b16 v[198:199], v8 offset:13568
    ds_read_b128 v[32:35], v9 offset:34816
    s_waitcnt lgkmcnt(7)
    v_mfma_f32_32x32x16_bf16 v[80:95], v[36:39], v[188:191], v[80:95]
    ds_read_b128 v[36:39], v9 offset:35840
    v_mfma_f32_16x16x32_bf16 v[20:23], v[16:19], v[188:191], v[20:23]
    v_add_f32 v40, v40, v41
    s_waitcnt lgkmcnt(2)
    s_barrier
    v_mfma_f32_32x32x16_bf16 v[64:79], v[24:27], v[192:195], v[64:79]
    ds_read_b64_tr_b16 v[200:201], v8 offset:17408
    ds_read_b64_tr_b16 v[202:203], v8 offset:17920
    ds_read_b128 v[24:27], v9 offset:36864
    v_mfma_f32_32x32x16_bf16 v[80:95], v[28:31], v[192:195], v[80:95]
    ds_read_b128 v[28:31], v9 offset:37888
    v_mfma_f32_16x16x32_bf16 v[20:23], v[16:19], v[192:195], v[20:23]
    ds_write_b32 v14, v40
    s_waitcnt lgkmcnt(6)
    v_mfma_f32_32x32x16_bf16 v[64:79], v[32:35], v[196:199], v[64:79]
    ds_read_b64_tr_b16 v[204:205], v8 offset:21760
    ds_read_b64_tr_b16 v[206:207], v8 offset:22272
    ds_read_b128 v[32:35], v9 offset:38912
    s_waitcnt lgkmcnt(8)
    v_mfma_f32_32x32x16_bf16 v[80:95], v[36:39], v[196:199], v[80:95]
    ds_read_b128 v[36:39], v9 offset:39936
    v_mfma_f32_16x16x32_bf16 v[20:23], v[16:19], v[196:199], v[20:23]
    s_waitcnt lgkmcnt(2)
    s_barrier
    v_mfma_f32_32x32x16_bf16 v[64:79], v[24:27], v[200:203], v[64:79]
    ds_read_b64_tr_b16 v[208:209], v8 offset:26112
    ds_read_b64_tr_b16 v[210:211], v8 offset:26624
    ds_read_b128 v[24:27], v9 offset:40960
    v_mfma_f32_32x32x16_bf16 v[80:95], v[28:31], v[200:203], v[80:95]
    ds_read_b128 v[28:31], v9 offset:41984
    v_mfma_f32_16x16x32_bf16 v[20:23], v[16:19], v[200:203], v[20:23]
    s_waitcnt lgkmcnt(5)
    v_mfma_f32_32x32x16_bf16 v[64:79], v[32:35], v[204:207], v[64:79]
    ds_read_b64_tr_b16 v[212:213], v8 offset:30464
    ds_read_b64_tr_b16 v[214:215], v8 offset:30976
    ds_read_b128 v[32:35], v9 offset:43008
    s_waitcnt lgkmcnt(7)
    v_mfma_f32_32x32x16_bf16 v[80:95], v[36:39], v[204:207], v[80:95]
    ds_read_b128 v[36:39], v9 offset:44032
    v_mfma_f32_16x16x32_bf16 v[20:23], v[16:19], v[204:207], v[20:23]
    s_waitcnt lgkmcnt(2)
    s_barrier
    v_mfma_f32_32x32x16_bf16 v[64:79], v[24:27], v[208:211], v[64:79]
    ds_read_b64_tr_b16 v[216:217], v8 offset:34816
    ds_read_b64_tr_b16 v[218:219], v8 offset:35328
    ds_read_b128 v[24:27], v9 offset:45056
    v_mfma_f32_32x32x16_bf16 v[80:95], v[28:31], v[208:211], v[80:95]
    ds_read_b128 v[28:31], v9 offset:46080
    v_mfma_f32_16x16x32_bf16 v[20:23], v[16:19], v[208:211], v[20:23]
    s_waitcnt lgkmcnt(5)
    v_mfma_f32_32x32x16_bf16 v[64:79], v[32:35], v[212:215], v[64:79]
    ds_read_b64_tr_b16 v[220:221], v8 offset:39168
    ds_read_b64_tr_b16 v[222:223], v8 offset:39680
    ds_read_b128 v[32:35], v9 offset:47104
    s_waitcnt lgkmcnt(7)
    v_mfma_f32_32x32x16_bf16 v[80:95], v[36:39], v[212:215], v[80:95]
    ds_read_b128 v[36:39], v9 offset:48128
    v_mfma_f32_16x16x32_bf16 v[20:23], v[16:19], v[212:215], v[20:23]
    s_waitcnt lgkmcnt(2)
    s_barrier
    v_mfma_f32_32x32x16_bf16 v[64:79], v[24:27], v[216:219], v[64:79]
    ds_read_b64_tr_b16 v[224:225], v8 offset:43520
    ds_read_b64_tr_b16 v[226:227], v8 offset:44032
    ds_read_b128 v[24:27], v9 offset:49152
    v_mfma_f32_32x32x16_bf16 v[80:95], v[28:31], v[216:219], v[80:95]
    ds_read_b128 v[28:31], v9 offset:50176
    v_mfma_f32_16x16x32_bf16 v[20:23], v[16:19], v[216:219], v[20:23]
    ds_read_b128 v[40:43], v10 offset:0
    s_waitcnt lgkmcnt(6)
    v_mfma_f32_32x32x16_bf16 v[64:79], v[32:35], v[220:223], v[64:79]
    ds_read_b64_tr_b16 v[228:229], v8 offset:47872
    ds_read_b64_tr_b16 v[230:231], v8 offset:48384
    ds_read_b128 v[32:35], v9 offset:51200
    s_waitcnt lgkmcnt(8)
    v_mfma_f32_32x32x16_bf16 v[80:95], v[36:39], v[220:223], v[80:95]
    ds_read_b128 v[36:39], v9 offset:52224
    v_mfma_f32_16x16x32_bf16 v[20:23], v[16:19], v[220:223], v[20:23]
    ds_read_b128 v[44:47], v10 offset:32
    s_waitcnt lgkmcnt(3)
    s_barrier
    v_mfma_f32_32x32x16_bf16 v[64:79], v[24:27], v[224:227], v[64:79]
    ds_read_b64_tr_b16 v[232:233], v8 offset:52224
    ds_read_b64_tr_b16 v[234:235], v8 offset:52736
    ds_read_b128 v[24:27], v9 offset:53248
    v_mfma_f32_32x32x16_bf16 v[80:95], v[28:31], v[224:227], v[80:95]
    ds_read_b128 v[28:31], v9 offset:54272
    v_mfma_f32_16x16x32_bf16 v[20:23], v[16:19], v[224:227], v[20:23]
    ds_read_b128 v[48:51], v10 offset:64
    s_waitcnt lgkmcnt(7)
    v_mfma_f32_32x32x16_bf16 v[64:79], v[32:35], v[228:231], v[64:79]
    ds_read_b64_tr_b16 v[236:237], v8 offset:56576
    ds_read_b64_tr_b16 v[238:239], v8 offset:57088
    ds_read_b128 v[32:35], v9 offset:55296
    s_waitcnt lgkmcnt(9)
    v_mfma_f32_32x32x16_bf16 v[80:95], v[36:39], v[228:231], v[80:95]
    ds_read_b128 v[36:39], v9 offset:56320
    v_mfma_f32_16x16x32_bf16 v[20:23], v[16:19], v[228:231], v[20:23]
    ds_read_b128 v[52:55], v10 offset:96
    s_waitcnt lgkmcnt(3)
    s_barrier
    v_mfma_f32_32x32x16_bf16 v[64:79], v[24:27], v[232:235], v[64:79]
    ds_read_b64_tr_b16 v[240:241], v8 offset:0
    ds_read_b64_tr_b16 v[242:243], v8 offset:512
    ds_read_b128 v[24:27], v9 offset:57344
    v_mfma_f32_32x32x16_bf16 v[80:95], v[28:31], v[232:235], v[80:95]
    ds_read_b128 v[28:31], v9 offset:58368
    v_mfma_f32_16x16x32_bf16 v[20:23], v[16:19], v[232:235], v[20:23]
    s_waitcnt lgkmcnt(6)
    v_mfma_f32_32x32x16_bf16 v[64:79], v[32:35], v[236:239], v[64:79]
    ds_read_b64_tr_b16 v[244:245], v8 offset:4352
    ds_read_b64_tr_b16 v[246:247], v8 offset:4864
    ds_read_b128 v[32:35], v9 offset:59392
    s_waitcnt lgkmcnt(8)
    v_mfma_f32_32x32x16_bf16 v[80:95], v[36:39], v[236:239], v[80:95]
    ds_read_b128 v[36:39], v9 offset:60416
    v_mfma_f32_16x16x32_bf16 v[20:23], v[16:19], v[236:239], v[20:23]
    s_waitcnt lgkmcnt(2)
    s_barrier
    v_mfma_f32_32x32x16_bf16 v[64:79], v[24:27], v[240:243], v[64:79]
    ds_read_b64_tr_b16 v[248:249], v8 offset:8704
    ds_read_b64_tr_b16 v[250:251], v8 offset:9216
    ds_read_b128 v[24:27], v9 offset:61440
    v_mfma_f32_32x32x16_bf16 v[80:95], v[28:31], v[240:243], v[80:95]
    ds_read_b128 v[28:31], v9 offset:62464
    v_mfma_f32_16x16x32_bf16 v[20:23], v[16:19], v[240:243], v[20:23]
    s_waitcnt lgkmcnt(5)
    v_mfma_f32_32x32x16_bf16 v[64:79], v[32:35], v[244:247], v[64:79]
    ds_read_b64_tr_b16 v[252:253], v8 offset:13056
    ds_read_b64_tr_b16 v[254:255], v8 offset:13568
    ds_read_b128 v[32:35], v9 offset:63488
    s_waitcnt lgkmcnt(7)
    v_mfma_f32_32x32x16_bf16 v[80:95], v[36:39], v[244:247], v[80:95]
    ds_read_b128 v[36:39], v9 offset:64512
    v_mfma_f32_16x16x32_bf16 v[20:23], v[16:19], v[244:247], v[20:23]
    s_waitcnt lgkmcnt(5)
    v_mfma_f32_32x32x16_bf16 v[64:79], v[24:27], v[248:251], v[64:79]
    ds_read_b128 v[24:27], v127 offset:0
    s_waitcnt lgkmcnt(5)
    v_mfma_f32_32x32x16_bf16 v[80:95], v[28:31], v[248:251], v[80:95]
    ds_read_b128 v[28:31], v127 offset:2048
    v_mfma_f32_16x16x32_bf16 v[20:23], v[16:19], v[248:251], v[20:23]
    s_waitcnt lgkmcnt(4)
    v_mfma_f32_16x16x32_bf16 v[20:23], v[16:19], v[252:255], v[20:23]
    s_waitcnt lgkmcnt(3)
    v_mfma_f32_32x32x16_bf16 v[64:79], v[32:35], v[252:255], v[64:79]
    ds_read_b128 v[32:35], v127 offset:4096
    s_waitcnt lgkmcnt(3)
    v_mfma_f32_32x32x16_bf16 v[80:95], v[36:39], v[252:255], v[80:95]
    ds_read_b128 v[36:39], v127 offset:6144
    v_cmp_u_f32 vcc, v20, v20
    s_cbranch_vccnz kf_kernel_nf
kf_kernel_nfb:
    s_barrier
kf_kernel_de_m2u0:
    s_waitcnt lgkmcnt(2)
    v_mfma_f32_32x32x16_bf16 v[96:111], v[24:27], v[128:131], 0
    ds_read_b128 v[24:27], v127 offset:8192
    ds_read_b32 v15, v126 offset:88
    v_mfma_f32_32x32x16_bf16 v[96:111], v[28:31], v[132:135], v[96:111]
    ds_read_b128 v[28:31], v127 offset:10240
    v_mul_f32 v12, 0xbb000000, v20
    s_waitcnt lgkmcnt(3)
    v_mfma_f32_32x32x16_bf16 v[96:111], v[32:35], v[136:139], v[96:111]
    ds_read_b128 v[32:35], v127 offset:12288
    v_cvt_pk_bf16_f32 v12, v12, v12
    v_and_b32 v12, 0xffff0000, v12
    v_mfma_f32_32x32x16_bf16 v[96:111], v[36:39], v[140:143], v[96:111]
    ds_read_b128 v[36:39], v127 offset:14336
    s_waitcnt lgkmcnt(3)
    v_cmp_ne_u32 vcc, 0, v15
    s_cbranch_vccnz kf_kernel_cre
    v_fmac_f32 v64, v12, v40
    v_fmac_f32 v65, v12, v41
    v_fmac_f32 v66, v12, v42
    s_waitcnt lgkmcnt(2)
    v_mfma_f32_32x32x16_bf16 v[96:111], v[24:27], v[144:147], v[96:111]
    ds_read_b128 v[24:27], v127 offset:16384
    v_fmac_f32 v67, v12, v43
    v_fmac_f32 v68, v12, v44
    v_fmac_f32 v69, v12, v45
    v_fmac_f32 v70, v12, v46
    v_fmac_f32 v71, v12, v47
    v_mfma_f32_32x32x16_bf16 v[96:111], v[28:31], v[148:151], v[96:111]
    ds_read_b128 v[28:31], v127 offset:18432
    ds_read_b128 v[40:43], v10 offset:128
    v_cvt_pk_bf16_f32 v56, v64, v65
    v_cvt_pk_bf16_f32 v57, v66, v67
    v_cvt_pk_bf16_f32 v58, v68, v69
    s_cbranch_execz kf_kernel_dr
    s_waitcnt lgkmcnt(3)
    v_mfma_f32_32x32x16_bf16 v[96:111], v[32:35], v[152:155], v[96:111]
    ds_read_b128 v[32:35], v127 offset:20480
    ds_read_b128 v[44:47], v10 offset:160
    v_cvt_pk_bf16_f32 v59, v70, v71
    v_pk_max_i16 v56, v56, 0
    v_pk_max_i16 v58, v58, 0
    v_pk_max_i16 v57, v57, 0
    v_mfma_f32_32x32x16_bf16 v[96:111], v[36:39], v[156:159], v[96:111]
    ds_read_b128 v[36:39], v127 offset:22528
    v_pk_max_i16 v59, v59, 0
    v_or_b32 v56, v56, v112
    v_or_b32 v58, v58, v113
    buffer_store_dwordx4 v[56:59], v9, s[64:67], s36 offen offset:0 sc1
    s_waitcnt lgkmcnt(4)
    v_mfma_f32_32x32x16_bf16 v[96:111], v[24:27], v[160:163], v[96:111]
    ds_read_b128 v[24:27], v127 offset:24576
    v_fmac_f32 v72, v12, v48
    v_fmac_f32 v73, v12, v49
    v_fmac_f32 v74, v12, v50
    v_fmac_f32 v75, v12, v51
    v_fmac_f32 v76, v12, v52
    v_mfma_f32_32x32x16_bf16 v[96:111], v[28:31], v[164:167], v[96:111]
    ds_read_b128 v[28:31], v127 offset:26624
    v_fmac_f32 v77, v12, v53
    v_fmac_f32 v78, v12, v54
    v_fmac_f32 v79, v12, v55
    ds_read_b128 v[48:51], v10 offset:192
    s_waitcnt lgkmcnt(3)
    v_mfma_f32_32x32x16_bf16 v[96:111], v[32:35], v[168:171], v[96:111]
    ds_read_b128 v[32:35], v127 offset:28672
    v_cvt_pk_bf16_f32 v60, v72, v73
    v_cvt_pk_bf16_f32 v61, v74, v75
    v_cvt_pk_bf16_f32 v62, v76, v77
    ds_read_b128 v[52:55], v10 offset:224
    v_cvt_pk_bf16_f32 v63, v78, v79
    v_mfma_f32_32x32x16_bf16 v[96:111], v[36:39], v[172:175], v[96:111]
    ds_read_b128 v[36:39], v127 offset:30720
    v_pk_max_i16 v60, v60, 0
    v_pk_max_i16 v62, v62, 0
    v_pk_max_i16 v61, v61, 0
    v_pk_max_i16 v63, v63, 0
    s_waitcnt lgkmcnt(4)
    v_mfma_f32_32x32x16_bf16 v[96:111], v[24:27], v[176:179], v[96:111]
    ds_read_b64_tr_b16 v[24:25], v4 offset:0
    ds_read_b64_tr_b16 v[26:27], v4 offset:1024
    v_or_b32 v60, v60, v112
    v_or_b32 v62, v62, v113
    buffer_store_dwordx4 v[60:63], v9, s[64:67], s36 offen offset:1024 sc1
    v_fmac_f32 v80, v12, v40
    v_mfma_f32_32x32x16_bf16 v[96:111], v[28:31], v[180:183], v[96:111]
    ds_read_b64_tr_b16 v[28:29], v4 offset:2048
    ds_read_b64_tr_b16 v[30:31], v4 offset:3072
    v_fmac_f32 v81, v12, v41
    v_fmac_f32 v82, v12, v42
    v_fmac_f32 v83, v12, v43
    s_waitcnt lgkmcnt(4)
    v_mfma_f32_32x32x16_bf16 v[96:111], v[32:35], v[184:187], v[96:111]
    ds_read_b64_tr_b16 v[32:33], v4 offset:4096
    ds_read_b64_tr_b16 v[34:35], v4 offset:5120
    v_fmac_f32 v84, v12, v44
    v_fmac_f32 v85, v12, v45
    v_fmac_f32 v86, v12, v46
    v_fmac_f32 v87, v12, v47
    v_mfma_f32_32x32x16_bf16 v[96:111], v[36:39], v[188:191], v[96:111]
    ds_read_b64_tr_b16 v[36:37], v4 offset:6144
    ds_read_b64_tr_b16 v[38:39], v4 offset:7168
    ds_read_b128 v[40:43], v10 offset:256
    v_cvt_pk_bf16_f32 v56, v80, v81
    v_cvt_pk_bf16_f32 v57, v82, v83
    s_waitcnt lgkmcnt(5)
    v_mfma_f32_32x32x16_bf16 v[96:111], v[24:27], v[192:195], v[96:111]
    ds_read_b64_tr_b16 v[24:25], v4 offset:8192
    ds_read_b64_tr_b16 v[26:27], v4 offset:9216
    v_cvt_pk_bf16_f32 v58, v84, v85
    ds_read_b128 v[44:47], v10 offset:288
    v_cvt_pk_bf16_f32 v59, v86, v87
    v_pk_max_i16 v56, v56, 0
    v_mfma_f32_32x32x16_bf16 v[96:111], v[28:31], v[196:199], v[96:111]
    ds_read_b64_tr_b16 v[28:29], v4 offset:10240
    ds_read_b64_tr_b16 v[30:31], v4 offset:11264
    v_pk_max_i16 v58, v58, 0
    v_pk_max_i16 v57, v57, 0
    v_pk_max_i16 v59, v59, 0
    s_waitcnt lgkmcnt(6)
    v_mfma_f32_32x32x16_bf16 v[96:111], v[32:35], v[200:203], v[96:111]
    ds_read_b64_tr_b16 v[32:33], v4 offset:12288
    ds_read_b64_tr_b16 v[34:35], v4 offset:13312
    v_or_b32 v56, v56, v112
    v_or_b32 v58, v58, v113
    buffer_store_dwordx4 v[56:59], v9, s[64:67], s36 offen offset:2048 sc1
    v_fmac_f32 v88, v12, v48
    v_mfma_f32_32x32x16_bf16 v[96:111], v[36:39], v[204:207], v[96:111]
    ds_read_b64_tr_b16 v[36:37], v4 offset:14336
    ds_read_b64_tr_b16 v[38:39], v4 offset:15360
    v_fmac_f32 v89, v12, v49
    v_fmac_f32 v90, v12, v50
    v_fmac_f32 v91, v12, v51
    s_waitcnt lgkmcnt(4)
    v_mfma_f32_32x32x16_bf16 v[96:111], v[24:27], v[208:211], v[96:111]
    ds_read_b64_tr_b16 v[24:25], v4 offset:16384
    ds_read_b64_tr_b16 v[26:27], v4 offset:17408
    v_fmac_f32 v92, v12, v52
    v_fmac_f32 v93, v12, v53
    v_fmac_f32 v94, v12, v54
    v_fmac_f32 v95, v12, v55
    v_mfma_f32_32x32x16_bf16 v[96:111], v[28:31], v[212:215], v[96:111]
    ds_read_b64_tr_b16 v[28:29], v4 offset:18432
    ds_read_b64_tr_b16 v[30:31], v4 offset:19456
    ds_read_b128 v[48:51], v10 offset:320
    v_cvt_pk_bf16_f32 v60, v88, v89
    v_cvt_pk_bf16_f32 v61, v90, v91
    s_waitcnt lgkmcnt(5)
    v_mfma_f32_32x32x16_bf16 v[96:111], v[32:35], v[216:219], v[96:111]
    ds_read_b64_tr_b16 v[32:33], v4 offset:20480
    ds_read_b64_tr_b16 v[34:35], v4 offset:21504
    v_cvt_pk_bf16_f32 v62, v92, v93
    ds_read_b128 v[52:55], v10 offset:352
    v_cvt_pk_bf16_f32 v63, v94, v95
    v_pk_max_i16 v60, v60, 0
    v_mfma_f32_32x32x16_bf16 v[96:111], v[36:39], v[220:223], v[96:111]
    ds_read_b64_tr_b16 v[36:37], v4 offset:22528
    ds_read_b64_tr_b16 v[38:39], v4 offset:23552
    v_pk_max_i16 v62, v62, 0
    v_pk_max_i16 v61, v61, 0
    v_pk_max_i16 v63, v63, 0
    s_waitcnt lgkmcnt(6)
    v_mfma_f32_32x32x16_bf16 v[96:111], v[24:27], v[224:227], v[96:111]
    ds_read_b64_tr_b16 v[24:25], v4 offset:24576
    ds_read_b64_tr_b16 v[26:27], v4 offset:25600
    v_or_b32 v60, v60, v112
    v_or_b32 v62, v62, v113
    buffer_store_dwordx4 v[60:63], v9, s[64:67], s36 offen offset:3072 sc1
    v_mfma_f32_32x32x16_bf16 v[96:111], v[28:31], v[228:231], v[96:111]
    ds_read_b64_tr_b16 v[28:29], v4 offset:26624
    ds_read_b64_tr_b16 v[30:31], v4 offset:27648
    s_waitcnt lgkmcnt(4)
    v_mfma_f32_32x32x16_bf16 v[96:111], v[32:35], v[232:235], v[96:111]
    ds_read_b64_tr_b16 v[32:33], v4 offset:28672
    ds_read_b64_tr_b16 v[34:35], v4 offset:29696
    v_mfma_f32_32x32x16_bf16 v[96:111], v[36:39], v[236:239], v[96:111]
    ds_read_b64_tr_b16 v[36:37], v4 offset:30720
    ds_read_b64_tr_b16 v[38:39], v4 offset:31744
    s_waitcnt lgkmcnt(4)
    v_mfma_f32_32x32x16_bf16 v[96:111], v[24:27], v[240:243], v[96:111]
    ds_read_b128 v[24:27], v127 offset:1024
    v_mfma_f32_32x32x16_bf16 v[96:111], v[28:31], v[244:247], v[96:111]
    ds_read_b128 v[28:31], v127 offset:3072
    ds_read_b128 v[16:19], v126 offset:48
    s_waitcnt lgkmcnt(3)
    v_mfma_f32_32x32x16_bf16 v[96:111], v[32:35], v[248:251], v[96:111]
    ds_read_b128 v[32:35], v127 offset:5120
    v_mfma_f32_32x32x16_bf16 v[96:111], v[36:39], v[252:255], v[96:111]
    ds_read_b128 v[36:39], v127 offset:7168
    s_waitcnt lgkmcnt(3)
    v_mfma_f32_32x32x16_bf16 v[64:79], v[24:27], v[128:131], 0
    ds_read_b128 v[24:27], v127 offset:9216
    s_waitcnt lgkmcnt(3)
    v_min_u32 v16, v16, v17
    v_min3_u32 v16, v16, v18, v19
    v_cmp_gt_u32 vcc, 2, v16
    s_cbranch_vccnz kf_kernel_cs2s
kf_kernel_cs2b:
    v_mfma_f32_32x32x16_bf16 v[64:79], v[28:31], v[132:135], v[64:79]
    ds_read_b128 v[28:31], v127 offset:11264
    ds_read_b64_tr_b16 v[128:129], v114 offset:0
    v_fmac_f32 v96, v12, v40
    v_fmac_f32 v97, v12, v41
    v_fmac_f32 v98, v12, v42
    s_waitcnt lgkmcnt(3)
    v_mfma_f32_32x32x16_bf16 v[64:79], v[32:35], v[136:139], v[64:79]
    ds_read_b128 v[32:35], v127 offset:13312
    ds_read_b64_tr_b16 v[130:131], v114 offset:1024
    v_fmac_f32 v99, v12, v43
    v_fmac_f32 v100, v12, v44
    v_fmac_f32 v101, v12, v45
    v_fmac_f32 v102, v12, v46
    v_mfma_f32_32x32x16_bf16 v[64:79], v[36:39], v[140:143], v[64:79]
    ds_read_b128 v[36:39], v127 offset:15360
    ds_read_b64_tr_b16 v[132:133], v115 offset:0
    v_fmac_f32 v103, v12, v47
    ds_read_b128 v[40:43], v10 offset:384
    v_cvt_pk_bf16_f32 v56, v96, v97
    s_waitcnt lgkmcnt(6)
    v_mfma_f32_32x32x16_bf16 v[64:79], v[24:27], v[144:147], v[64:79]
    ds_read_b128 v[24:27], v127 offset:17408
    ds_read_b64_tr_b16 v[134:135], v115 offset:1024
    v_cvt_pk_bf16_f32 v57, v98, v99
    v_cvt_pk_bf16_f32 v58, v100, v101
    ds_read_b128 v[44:47], v10 offset:416
    v_cvt_pk_bf16_f32 v59, v102, v103
    v_mfma_f32_32x32x16_bf16 v[64:79], v[28:31], v[148:151], v[64:79]
    ds_read_b128 v[28:31], v127 offset:19456
    ds_read_b64_tr_b16 v[136:137], v114 offset:2048
    v_pk_max_i16 v56, v56, 0
    v_pk_max_i16 v58, v58, 0
    v_pk_max_i16 v57, v57, 0
    s_waitcnt lgkmcnt(7)
    v_mfma_f32_32x32x16_bf16 v[64:79], v[32:35], v[152:155], v[64:79]
    ds_read_b128 v[32:35], v127 offset:21504
    ds_read_b64_tr_b16 v[138:139], v114 offset:3072
    v_pk_max_i16 v59, v59, 0
    v_or_b32 v56, v56, v112
    v_or_b32 v58, v58, v113
    buffer_store_dwordx4 v[56:59], v9, s[64:67], s37 offen offset:0 sc1
    v_mfma_f32_32x32x16_bf16 v[64:79], v[36:39], v[156:159], v[64:79]
    ds_read_b128 v[36:39], v127 offset:23552
    ds_read_b64_tr_b16 v[140:141], v115 offset:2048
    v_fmac_f32 v104, v12, v48
    v_fmac_f32 v105, v12, v49
    v_fmac_f32 v106, v12, v50
    s_waitcnt lgkmcnt(5)
    v_mfma_f32_32x32x16_bf16 v[64:79], v[24:27], v[160:163], v[64:79]
    ds_read_b128 v[24:27], v127 offset:25600
    ds_read_b64_tr_b16 v[142:143], v115 offset:3072
    v_fmac_f32 v107, v12, v51
    v_fmac_f32 v108, v12, v52
    v_fmac_f32 v109, v12, v53
    v_fmac_f32 v110, v12, v54
    v_mfma_f32_32x32x16_bf16 v[64:79], v[28:31], v[164:167], v[64:79]
    ds_read_b128 v[28:31], v127 offset:27648
    ds_read_b64_tr_b16 v[144:145], v114 offset:4096
    v_fmac_f32 v111, v12, v55
    ds_read_b128 v[48:51], v10 offset:448
    v_cvt_pk_bf16_f32 v60, v104, v105
    s_waitcnt lgkmcnt(6)
    v_mfma_f32_32x32x16_bf16 v[64:79], v[32:35], v[168:171], v[64:79]
    ds_read_b128 v[32:35], v127 offset:29696
    ds_read_b64_tr_b16 v[146:147], v114 offset:5120
    v_cvt_pk_bf16_f32 v61, v106, v107
    v_cvt_pk_bf16_f32 v62, v108, v109
    ds_read_b128 v[52:55], v10 offset:480
    v_cvt_pk_bf16_f32 v63, v110, v111
    v_mfma_f32_32x32x16_bf16 v[64:79], v[36:39], v[172:175], v[64:79]
    ds_read_b128 v[36:39], v127 offset:31744
    ds_read_b64_tr_b16 v[148:149], v115 offset:4096
    v_pk_max_i16 v60, v60, 0
    v_pk_max_i16 v62, v62, 0
    v_pk_max_i16 v61, v61, 0
    s_waitcnt lgkmcnt(7)
    v_mfma_f32_32x32x16_bf16 v[64:79], v[24:27], v[176:179], v[64:79]
    ds_read_b64_tr_b16 v[24:25], v5 offset:0
    ds_read_b64_tr_b16 v[26:27], v5 offset:1024
    v_pk_max_i16 v63, v63, 0
    v_or_b32 v60, v60, v112
    v_or_b32 v62, v62, v113
    buffer_store_dwordx4 v[60:63], v9, s[64:67], s37 offen offset:1024 sc1
    v_mfma_f32_32x32x16_bf16 v[64:79], v[28:31], v[180:183], v[64:79]
    ds_read_b64_tr_b16 v[28:29], v5 offset:2048
    ds_read_b64_tr_b16 v[30:31], v5 offset:3072
    ds_read_b64_tr_b16 v[150:151], v115 offset:5120
    s_waitcnt lgkmcnt(6)
    v_mfma_f32_32x32x16_bf16 v[64:79], v[32:35], v[184:187], v[64:79]
    ds_read_b64_tr_b16 v[32:33], v5 offset:4096
    ds_read_b64_tr_b16 v[34:35], v5 offset:5120
    ds_read_b64_tr_b16 v[152:153], v114 offset:6144
    v_mfma_f32_32x32x16_bf16 v[64:79], v[36:39], v[188:191], v[64:79]
    ds_read_b64_tr_b16 v[36:37], v5 offset:6144
    ds_read_b64_tr_b16 v[38:39], v5 offset:7168
    ds_read_b64_tr_b16 v[154:155], v114 offset:7168
    s_waitcnt lgkmcnt(7)
    v_mfma_f32_32x32x16_bf16 v[64:79], v[24:27], v[192:195], v[64:79]
    ds_read_b64_tr_b16 v[24:25], v5 offset:8192
    ds_read_b64_tr_b16 v[26:27], v5 offset:9216
    ds_read_b64_tr_b16 v[156:157], v115 offset:6144
    v_mfma_f32_32x32x16_bf16 v[64:79], v[28:31], v[196:199], v[64:79]
    ds_read_b64_tr_b16 v[28:29], v5 offset:10240
    ds_read_b64_tr_b16 v[30:31], v5 offset:11264
    ds_read_b64_tr_b16 v[158:159], v115 offset:7168
    s_waitcnt lgkmcnt(7)
    v_mfma_f32_32x32x16_bf16 v[64:79], v[32:35], v[200:203], v[64:79]
    ds_read_b64_tr_b16 v[32:33], v5 offset:12288
    ds_read_b64_tr_b16 v[34:35], v5 offset:13312
    ds_read_b64_tr_b16 v[160:161], v116 offset:0
    v_mfma_f32_32x32x16_bf16 v[64:79], v[36:39], v[204:207], v[64:79]
    ds_read_b64_tr_b16 v[36:37], v5 offset:14336
    ds_read_b64_tr_b16 v[38:39], v5 offset:15360
    ds_read_b64_tr_b16 v[162:163], v116 offset:1024
    s_waitcnt lgkmcnt(7)
    v_mfma_f32_32x32x16_bf16 v[64:79], v[24:27], v[208:211], v[64:79]
    ds_read_b64_tr_b16 v[24:25], v5 offset:16384
    ds_read_b64_tr_b16 v[26:27], v5 offset:17408
    ds_read_b64_tr_b16 v[164:165], v117 offset:0
    v_mfma_f32_32x32x16_bf16 v[64:79], v[28:31], v[212:215], v[64:79]
    ds_read_b64_tr_b16 v[28:29], v5 offset:18432
    ds_read_b64_tr_b16 v[30:31], v5 offset:19456
    ds_read_b64_tr_b16 v[166:167], v117 offset:1024
    s_waitcnt lgkmcnt(7)
    v_mfma_f32_32x32x16_bf16 v[64:79], v[32:35], v[216:219], v[64:79]
    ds_read_b64_tr_b16 v[32:33], v5 offset:20480
    ds_read_b64_tr_b16 v[34:35], v5 offset:21504
    s_add_u32 s42, s45, 0
    s_add_u32 s43, s46, 0
    buffer_load_dwordx4 v[80:83], v9, s[64:67], s42 offen offset:0 sc1
    buffer_load_dwordx4 v[84:87], v9, s[64:67], s43 offen offset:0 sc1
    v_mfma_f32_32x32x16_bf16 v[64:79], v[36:39], v[220:223], v[64:79]
    ds_read_b64_tr_b16 v[36:37], v5 offset:22528
    ds_read_b64_tr_b16 v[38:39], v5 offset:23552
    ds_read_b64_tr_b16 v[168:169], v116 offset:2048
    s_waitcnt lgkmcnt(6)
    v_mfma_f32_32x32x16_bf16 v[64:79], v[24:27], v[224:227], v[64:79]
    ds_read_b64_tr_b16 v[24:25], v5 offset:24576
    ds_read_b64_tr_b16 v[26:27], v5 offset:25600
    buffer_load_dwordx4 v[88:91], v9, s[64:67], s42 offen offset:1024 sc1
    buffer_load_dwordx4 v[92:95], v9, s[64:67], s43 offen offset:1024 sc1
    ds_read_b64_tr_b16 v[170:171], v116 offset:3072
    v_mfma_f32_32x32x16_bf16 v[64:79], v[28:31], v[228:231], v[64:79]
    ds_read_b64_tr_b16 v[28:29], v5 offset:26624
    ds_read_b64_tr_b16 v[30:31], v5 offset:27648
    ds_read_b64_tr_b16 v[172:173], v117 offset:2048
    s_waitcnt lgkmcnt(7)
    v_mfma_f32_32x32x16_bf16 v[64:79], v[32:35], v[232:235], v[64:79]
    ds_read_b64_tr_b16 v[32:33], v5 offset:28672
    ds_read_b64_tr_b16 v[34:35], v5 offset:29696
    buffer_load_dwordx4 v[96:99], v9, s[64:67], s42 offen offset:2048 sc1
    buffer_load_dwordx4 v[100:103], v9, s[64:67], s43 offen offset:2048 sc1
    ds_read_b64_tr_b16 v[174:175], v117 offset:3072
    v_mfma_f32_32x32x16_bf16 v[64:79], v[36:39], v[236:239], v[64:79]
    ds_read_b64_tr_b16 v[36:37], v5 offset:30720
    ds_read_b64_tr_b16 v[38:39], v5 offset:31744
    ds_read_b64_tr_b16 v[176:177], v116 offset:4096
    s_waitcnt lgkmcnt(7)
    v_mfma_f32_32x32x16_bf16 v[64:79], v[24:27], v[240:243], v[64:79]
    buffer_load_dwordx4 v[104:107], v9, s[64:67], s42 offen offset:3072 sc1
    buffer_load_dwordx4 v[108:111], v9, s[64:67], s43 offen offset:3072 sc1
    ds_read_b64_tr_b16 v[178:179], v116 offset:5120
    ds_read_b64_tr_b16 v[180:181], v117 offset:4096
    ds_read_b64_tr_b16 v[182:183], v117 offset:5120
    v_mfma_f32_32x32x16_bf16 v[64:79], v[28:31], v[244:247], v[64:79]
    v_mov_b32 v14, 3
    ds_read_b64_tr_b16 v[184:185], v116 offset:6144
    ds_read_b64_tr_b16 v[186:187], v116 offset:7168
    ds_read_b64_tr_b16 v[188:189], v117 offset:6144
    s_waitcnt lgkmcnt(7)
    v_mfma_f32_32x32x16_bf16 v[64:79], v[32:35], v[248:251], v[64:79]
    ds_read_b64_tr_b16 v[190:191], v117 offset:7168
    v_mfma_f32_32x32x16_bf16 v[64:79], v[36:39], v[252:255], v[64:79]
    s_add_u32 s42, s45, 8192
    s_add_u32 s43, s46, 8192
    buffer_load_dwordx4 v[24:27], v9, s[64:67], s42 offen offset:0 sc1
    buffer_load_dwordx4 v[28:31], v9, s[64:67], s43 offen offset:0 sc1
    buffer_load_dwordx4 v[32:35], v9, s[64:67], s42 offen offset:1024 sc1
    buffer_load_dwordx4 v[36:39], v9, s[64:67], s43 offen offset:1024 sc1
    s_waitcnt lgkmcnt(0)
    ds_write_b32 v11, v14
    s_nop 3
    v_pk_fma_f32 v[64:65], v[12:13], v[40:41], v[64:65] op_sel:[0,0,0] op_sel_hi:[0,1,1]
    v_pk_fma_f32 v[66:67], v[12:13], v[42:43], v[66:67] op_sel:[0,0,0] op_sel_hi:[0,1,1]
    v_pk_fma_f32 v[68:69], v[12:13], v[44:45], v[68:69] op_sel:[0,0,0] op_sel_hi:[0,1,1]
    v_pk_fma_f32 v[70:71], v[12:13], v[46:47], v[70:71] op_sel:[0,0,0] op_sel_hi:[0,1,1]
    v_pk_fma_f32 v[72:73], v[12:13], v[48:49], v[72:73] op_sel:[0,0,0] op_sel_hi:[0,1,1]
    v_pk_fma_f32 v[74:75], v[12:13], v[50:51], v[74:75] op_sel:[0,0,0] op_sel_hi:[0,1,1]
    v_pk_fma_f32 v[76:77], v[12:13], v[52:53], v[76:77] op_sel:[0,0,0] op_sel_hi:[0,1,1]
    v_pk_fma_f32 v[78:79], v[12:13], v[54:55], v[78:79] op_sel:[0,0,0] op_sel_hi:[0,1,1]
    buffer_load_dwordx4 v[40:43], v9, s[64:67], s42 offen offset:2048 sc1
    buffer_load_dwordx4 v[44:47], v9, s[64:67], s43 offen offset:2048 sc1
    buffer_load_dwordx4 v[48:51], v9, s[64:67], s42 offen offset:3072 sc1
    buffer_load_dwordx4 v[52:55], v9, s[64:67], s43 offen offset:3072 sc1
    v_cvt_pk_bf16_f32 v56, v64, v65
    v_cvt_pk_bf16_f32 v57, v66, v67
    v_cvt_pk_bf16_f32 v58, v68, v69
    v_cvt_pk_bf16_f32 v59, v70, v71
    v_pk_max_i16 v56, v56, 0
    v_pk_max_i16 v58, v58, 0
    v_pk_max_i16 v57, v57, 0
    v_pk_max_i16 v59, v59, 0
    v_or_b32 v56, v56, v112
    v_or_b32 v58, v58, v113
    v_cvt_pk_bf16_f32 v60, v72, v73
    v_cvt_pk_bf16_f32 v61, v74, v75
    v_cvt_pk_bf16_f32 v62, v76, v77
    v_cvt_pk_bf16_f32 v63, v78, v79
    v_pk_max_i16 v60, v60, 0
    v_pk_max_i16 v62, v62, 0
    v_pk_max_i16 v61, v61, 0
    v_pk_max_i16 v63, v63, 0
    v_or_b32 v60, v60, v112
    v_or_b32 v62, v62, v113
    buffer_store_dwordx4 v[56:59], v9, s[64:67], s37 offen offset:2048 sc1
    buffer_store_dwordx4 v[60:63], v9, s[64:67], s37 offen offset:3072 sc1
kf_kernel_cskip:
    s_waitcnt vmcnt(16)
    v_xor_b32 v80, v80, v112
    v_xor_b32 v82, v82, v113
    v_xor_b32 v84, v84, v112
    v_xor_b32 v86, v86, v113
    v_or3_b32 v56, v80, v82, v84
    v_or_b32 v56, v56, v86
    v_and_b32 v56, 0x80008000, v56
    v_cmp_ne_u32 vcc, 0, v56
    s_cbranch_vccnz kf_kernel_hr0
kf_kernel_hk0:
    v_mfma_f32_32x32x16_bf16 v[192:207], v[128:131], v[80:83], 0
    s_waitcnt vmcnt(14)
    v_xor_b32 v88, v88, v112
    v_xor_b32 v90, v90, v113
    v_xor_b32 v92, v92, v112
    v_xor_b32 v94, v94, v113
    v_mfma_f32_32x32x16_bf16 v[208:223], v[128:131], v[84:87], 0
    v_or3_b32 v56, v88, v90, v92
    v_or_b32 v56, v56, v94
    v_and_b32 v56, 0x80008000, v56
    v_cmp_ne_u32 vcc, 0, v56
    v_mfma_f32_32x32x16_bf16 v[224:239], v[132:135], v[80:83], 0
    s_cbranch_vccnz kf_kernel_hr1
kf_kernel_hk1:
    s_add_u32 s42, s45, 16384
    s_add_u32 s43, s46, 16384
    buffer_load_dwordx4 v[80:83], v9, s[64:67], s42 offen offset:0 sc1
    v_mfma_f32_32x32x16_bf16 v[240:255], v[132:135], v[84:87], 0
    buffer_load_dwordx4 v[84:87], v9, s[64:67], s43 offen offset:0 sc1
    v_mfma_f32_32x32x16_bf16 v[192:207], v[136:139], v[88:91], v[192:207]
    s_waitcnt vmcnt(14)
    v_xor_b32 v96, v96, v112
    v_xor_b32 v98, v98, v113
    v_xor_b32 v100, v100, v112
    v_xor_b32 v102, v102, v113
    v_mfma_f32_32x32x16_bf16 v[208:223], v[136:139], v[92:95], v[208:223]
    v_or3_b32 v56, v96, v98, v100
    v_or_b32 v56, v56, v102
    v_and_b32 v56, 0x80008000, v56
    v_cmp_ne_u32 vcc, 0, v56
    v_mfma_f32_32x32x16_bf16 v[224:239], v[140:143], v[88:91], v[224:239]
    s_cbranch_vccnz kf_kernel_hr2
kf_kernel_hk2:
    buffer_load_dwordx4 v[88:91], v9, s[64:67], s42 offen offset:1024 sc1
    v_mfma_f32_32x32x16_bf16 v[240:255], v[140:143], v[92:95], v[240:255]
    buffer_load_dwordx4 v[92:95], v9, s[64:67], s43 offen offset:1024 sc1
    v_mfma_f32_32x32x16_bf16 v[192:207], v[144:147], v[96:99], v[192:207]
    s_waitcnt vmcnt(14)
    v_xor_b32 v104, v104, v112
    v_xor_b32 v106, v106, v113
    v_xor_b32 v108, v108, v112
    v_xor_b32 v110, v110, v113
    v_mfma_f32_32x32x16_bf16 v[208:223], v[144:147], v[100:103], v[208:223]
    v_or3_b32 v56, v104, v106, v108
    v_or_b32 v56, v56, v110
    v_and_b32 v56, 0x80008000, v56
    v_cmp_ne_u32 vcc, 0, v56
    v_mfma_f32_32x32x16_bf16 v[224:239], v[148:151], v[96:99], v[224:239]
    s_cbranch_vccnz kf_kernel_hr3
kf_kernel_hk3:
    buffer_load_dwordx4 v[96:99], v9, s[64:67], s42 offen offset:2048 sc1
    v_mfma_f32_32x32x16_bf16 v[240:255], v[148:151], v[100:103], v[240:255]
    buffer_load_dwordx4 v[100:103], v9, s[64:67], s43 offen offset:2048 sc1
    v_mfma_f32_32x32x16_bf16 v[192:207], v[152:155], v[104:107], v[192:207]
    s_waitcnt vmcnt(14)
    v_xor_b32 v24, v24, v112
    v_xor_b32 v26, v26, v113
    v_xor_b32 v28, v28, v112
    v_xor_b32 v30, v30, v113
    v_mfma_f32_32x32x16_bf16 v[208:223], v[152:155], v[108:111], v[208:223]
    v_or3_b32 v56, v24, v26, v28
    v_or_b32 v56, v56, v30
    v_and_b32 v56, 0x80008000, v56
    v_cmp_ne_u32 vcc, 0, v56
    v_mfma_f32_32x32x16_bf16 v[224:239], v[156:159], v[104:107], v[224:239]
    s_cbranch_vccnz kf_kernel_hr4
kf_kernel_hk4:
    buffer_load_dwordx4 v[104:107], v9, s[64:67], s42 offen offset:3072 sc1
    v_mfma_f32_32x32x16_bf16 v[240:255], v[156:159], v[108:111], v[240:255]
    buffer_load_dwordx4 v[108:111], v9, s[64:67], s43 offen offset:3072 sc1
    v_mfma_f32_32x32x16_bf16 v[192:207], v[160:163], v[24:27], v[192:207]
    s_waitcnt vmcnt(14)
    v_xor_b32 v32, v32, v112
    v_xor_b32 v34, v34, v113
    v_xor_b32 v36, v36, v112
    v_xor_b32 v38, v38, v113
    v_mfma_f32_32x32x16_bf16 v[208:223], v[160:163], v[28:31], v[208:223]
    v_or3_b32 v56, v32, v34, v36
    v_or_b32 v56, v56, v38
    v_and_b32 v56, 0x80008000, v56
    v_cmp_ne_u32 vcc, 0, v56
    v_mfma_f32_32x32x16_bf16 v[224:239], v[164:167], v[24:27], v[224:239]
    s_cbranch_vccnz kf_kernel_hr5
kf_kernel_hk5:
    s_add_u32 s42, s58, 0
    s_add_u32 s43, s59, 0
    buffer_load_dwordx4 v[24:27], v9, s[64:67], s42 offen offset:0 sc1
    v_mfma_f32_32x32x16_bf16 v[240:255], v[164:167], v[28:31], v[240:255]
    buffer_load_dwordx4 v[28:31], v9, s[64:67], s43 offen offset:0 sc1
    v_mfma_f32_32x32x16_bf16 v[192:207], v[168:171], v[32:35], v[192:207]
    ds_read_b32 v60, v125
    s_waitcnt vmcnt(14)
    v_xor_b32 v40, v40, v112
    v_xor_b32 v42, v42, v113
    v_xor_b32 v44, v44, v112
    v_xor_b32 v46, v46, v113
    v_mfma_f32_32x32x16_bf16 v[208:223], v[168:171], v[36:39], v[208:223]
    v_or3_b32 v56, v40, v42, v44
    v_or_b32 v56, v56, v46
    v_and_b32 v56, 0x80008000, v56
    v_cmp_ne_u32 vcc, 0, v56
    v_mfma_f32_32x32x16_bf16 v[224:239], v[172:175], v[32:35], v[224:239]
    s_cbranch_vccnz kf_kernel_hr6
kf_kernel_hk6:
    buffer_load_dwordx4 v[32:35], v9, s[64:67], s42 offen offset:1024 sc1
    v_mfma_f32_32x32x16_bf16 v[240:255], v[172:175], v[36:39], v[240:255]
    buffer_load_dwordx4 v[36:39], v9, s[64:67], s43 offen offset:1024 sc1
    s_waitcnt lgkmcnt(0)
    v_cmp_gt_u32 vcc, 3, v60
    s_cbranch_vccnz kf_kernel_c6s
kf_kernel_c6b:
    v_mfma_f32_32x32x16_bf16 v[192:207], v[176:179], v[40:43], v[192:207]
    s_waitcnt vmcnt(14)
    v_xor_b32 v48, v48, v112
    v_xor_b32 v50, v50, v113
    v_xor_b32 v52, v52, v112
    v_xor_b32 v54, v54, v113
    v_mfma_f32_32x32x16_bf16 v[208:223], v[176:179], v[44:47], v[208:223]
    v_or3_b32 v56, v48, v50, v52
    v_or_b32 v56, v56, v54
    v_and_b32 v56, 0x80008000, v56
    v_cmp_ne_u32 vcc, 0, v56
    ds_read_b64_tr_b16 v[64:65], v118 offset:0
    ds_read_b64_tr_b16 v[66:67], v118 offset:1024
    v_mfma_f32_32x32x16_bf16 v[224:239], v[180:183], v[40:43], v[224:239]
    s_cbranch_vccnz kf_kernel_hr7
kf_kernel_hk7:
    s_add_u32 s42, s45, 4096
    s_add_u32 s43, s46, 4096
    buffer_load_dwordx4 v[40:43], v9, s[64:67], s42 offen offset:0 sc1
    v_mfma_f32_32x32x16_bf16 v[240:255], v[180:183], v[44:47], v[240:255]
    buffer_load_dwordx4 v[44:47], v9, s[64:67], s43 offen offset:0 sc1
    ds_read_b64_tr_b16 v[68:69], v119 offset:0
    ds_read_b64_tr_b16 v[70:71], v119 offset:1024
    v_mfma_f32_32x32x16_bf16 v[192:207], v[184:187], v[48:51], v[192:207]
    s_waitcnt vmcnt(12)
    v_xor_b32 v80, v80, v112
    v_xor_b32 v82, v82, v113
    v_xor_b32 v84, v84, v112
    v_xor_b32 v86, v86, v113
    v_mfma_f32_32x32x16_bf16 v[208:223], v[184:187], v[52:55], v[208:223]
    v_or3_b32 v56, v80, v82, v84
    v_or_b32 v56, v56, v86
    v_and_b32 v56, 0x80008000, v56
    v_cmp_ne_u32 vcc, 0, v56
    ds_read_b64_tr_b16 v[72:73], v118 offset:2048
    ds_read_b64_tr_b16 v[74:75], v118 offset:3072
    v_mfma_f32_32x32x16_bf16 v[224:239], v[188:191], v[48:51], v[224:239]
    s_cbranch_vccnz kf_kernel_hr8
kf_kernel_hk8:
    buffer_load_dwordx4 v[48:51], v9, s[64:67], s42 offen offset:1024 sc1
    v_mfma_f32_32x32x16_bf16 v[240:255], v[188:191], v[52:55], v[240:255]
    buffer_load_dwordx4 v[52:55], v9, s[64:67], s43 offen offset:1024 sc1
    ds_read_b64_tr_b16 v[76:77], v119 offset:2048
    ds_read_b64_tr_b16 v[78:79], v119 offset:3072
    s_waitcnt lgkmcnt(4)
    v_mfma_f32_32x32x16_bf16 v[192:207], v[64:67], v[80:83], v[192:207]
    s_waitcnt vmcnt(12)
    v_xor_b32 v88, v88, v112
    v_xor_b32 v90, v90, v113
    v_xor_b32 v92, v92, v112
    v_xor_b32 v94, v94, v113
    v_mfma_f32_32x32x16_bf16 v[208:223], v[64:67], v[84:87], v[208:223]
    v_or3_b32 v56, v88, v90, v92
    v_or_b32 v56, v56, v94
    v_and_b32 v56, 0x80008000, v56
    v_cmp_ne_u32 vcc, 0, v56
    ds_read_b64_tr_b16 v[64:65], v118 offset:4096
    ds_read_b64_tr_b16 v[66:67], v118 offset:5120
    v_mfma_f32_32x32x16_bf16 v[224:239], v[68:71], v[80:83], v[224:239]
    s_cbranch_vccnz kf_kernel_hr9
kf_kernel_hk9:
    s_add_u32 s42, s45, 12288
    s_add_u32 s43, s46, 12288
    buffer_load_dwordx4 v[80:83], v9, s[64:67], s42 offen offset:0 sc1
    v_mfma_f32_32x32x16_bf16 v[240:255], v[68:71], v[84:87], v[240:255]
    buffer_load_dwordx4 v[84:87], v9, s[64:67], s43 offen offset:0 sc1
    ds_read_b64_tr_b16 v[68:69], v119 offset:4096
    ds_read_b64_tr_b16 v[70:71], v119 offset:5120
    s_waitcnt lgkmcnt(4)
    v_mfma_f32_32x32x16_bf16 v[192:207], v[72:75], v[88:91], v[192:207]
    ds_read_b32 v60, v125
    s_waitcnt vmcnt(12)
    v_xor_b32 v96, v96, v112
    v_xor_b32 v98, v98, v113
    v_xor_b32 v100, v100, v112
    v_xor_b32 v102, v102, v113
    v_mfma_f32_32x32x16_bf16 v[208:223], v[72:75], v[92:95], v[208:223]
    v_or3_b32 v56, v96, v98, v100
    v_or_b32 v56, v56, v102
    v_and_b32 v56, 0x80008000, v56
    v_cmp_ne_u32 vcc, 0, v56
    ds_read_b64_tr_b16 v[72:73], v118 offset:6144
    ds_read_b64_tr_b16 v[74:75], v118 offset:7168
    v_mfma_f32_32x32x16_bf16 v[224:239], v[76:79], v[88:91], v[224:239]
    s_cbranch_vccnz kf_kernel_hr10
kf_kernel_hk10:
    buffer_load_dwordx4 v[88:91], v9, s[64:67], s42 offen offset:1024 sc1
    v_mfma_f32_32x32x16_bf16 v[240:255], v[76:79], v[92:95], v[240:255]
    buffer_load_dwordx4 v[92:95], v9, s[64:67], s43 offen offset:1024 sc1
    ds_read_b64_tr_b16 v[76:77], v119 offset:6144
    ds_read_b64_tr_b16 v[78:79], v119 offset:7168
    s_waitcnt lgkmcnt(4)
    v_cmp_gt_u32 vcc, 4, v60
    s_cbranch_vccnz kf_kernel_c10s
kf_kernel_c10b:
    v_mfma_f32_32x32x16_bf16 v[192:207], v[64:67], v[96:99], v[192:207]
    s_waitcnt vmcnt(12)
    v_xor_b32 v104, v104, v112
    v_xor_b32 v106, v106, v113
    v_xor_b32 v108, v108, v112
    v_xor_b32 v110, v110, v113
    v_mfma_f32_32x32x16_bf16 v[208:223], v[64:67], v[100:103], v[208:223]
    v_or3_b32 v56, v104, v106, v108
    v_or_b32 v56, v56, v110
    v_and_b32 v56, 0x80008000, v56
    v_cmp_ne_u32 vcc, 0, v56
    ds_read_b64_tr_b16 v[64:65], v120 offset:0
    ds_read_b64_tr_b16 v[66:67], v120 offset:1024
    v_mfma_f32_32x32x16_bf16 v[224:239], v[68:71], v[96:99], v[224:239]
    s_cbranch_vccnz kf_kernel_hr11
kf_kernel_hk11:
    s_add_u32 s42, s58, 0
    s_add_u32 s43, s59, 0
    buffer_load_dwordx4 v[96:99], v9, s[64:67], s42 offen offset:2048 sc1
    v_mov_b32 v62, 5
    v_mfma_f32_32x32x16_bf16 v[240:255], v[68:71], v[100:103], v[240:255]
    buffer_load_dwordx4 v[100:103], v9, s[64:67], s43 offen offset:2048 sc1
    ds_read_b64_tr_b16 v[68:69], v121 offset:0
    ds_read_b64_tr_b16 v[70:71], v121 offset:1024
    s_waitcnt lgkmcnt(4)
    v_mfma_f32_32x32x16_bf16 v[192:207], v[72:75], v[104:107], v[192:207]
    ds_write_b32 v11, v62
    ds_read_b32 v60, v125
    s_waitcnt vmcnt(12)
    v_xor_b32 v24, v24, v112
    v_xor_b32 v26, v26, v113
    v_xor_b32 v28, v28, v112
    v_xor_b32 v30, v30, v113
    v_mfma_f32_32x32x16_bf16 v[208:223], v[72:75], v[108:111], v[208:223]
    v_or3_b32 v56, v24, v26, v28
    v_or_b32 v56, v56, v30
    v_and_b32 v56, 0x80008000, v56
    v_cmp_ne_u32 vcc, 0, v56
    ds_read_b64_tr_b16 v[72:73], v120 offset:2048
    ds_read_b64_tr_b16 v[74:75], v120 offset:3072
    v_mfma_f32_32x32x16_bf16 v[224:239], v[76:79], v[104:107], v[224:239]
    s_cbranch_vccnz kf_kernel_hr12
kf_kernel_hk12:
    buffer_load_dwordx4 v[104:107], v9, s[64:67], s42 offen offset:3072 sc1
    v_mfma_f32_32x32x16_bf16 v[240:255], v[76:79], v[108:111], v[240:255]
    buffer_load_dwordx4 v[108:111], v9, s[64:67], s43 offen offset:3072 sc1
    ds_read_b64_tr_b16 v[76:77], v121 offset:2048
    ds_read_b64_tr_b16 v[78:79], v121 offset:3072
    s_waitcnt lgkmcnt(4)
    v_cmp_gt_u32 vcc, 5, v60
    s_cbranch_vccnz kf_kernel_c12s
kf_kernel_c12b:
    v_mfma_f32_32x32x16_bf16 v[192:207], v[64:67], v[24:27], v[192:207]
    s_waitcnt vmcnt(12)
    v_xor_b32 v32, v32, v112
    v_xor_b32 v34, v34, v113
    v_xor_b32 v36, v36, v112
    v_xor_b32 v38, v38, v113
    v_mfma_f32_32x32x16_bf16 v[208:223], v[64:67], v[28:31], v[208:223]
    v_or3_b32 v56, v32, v34, v36
    v_or_b32 v56, v56, v38
    v_and_b32 v56, 0x80008000, v56
    v_cmp_ne_u32 vcc, 0, v56
    ds_read_b64_tr_b16 v[64:65], v114 offset:0
    ds_read_b64_tr_b16 v[66:67], v114 offset:1024
    v_mfma_f32_32x32x16_bf16 v[224:239], v[68:71], v[24:27], v[224:239]
    s_cbranch_vccnz kf_kernel_hr13
kf_kernel_hk13:
    s_add_u32 s43, s46, 20480
    buffer_load_dwordx4 v[24:27], v9, s[64:67], s43 offen offset:0 sc1
    v_mfma_f32_32x32x16_bf16 v[240:255], v[68:71], v[28:31], v[240:255]
    buffer_load_dwordx4 v[28:31], v9, s[64:67], s43 offen offset:1024 sc1
    ds_read_b64_tr_b16 v[68:69], v115 offset:0
    ds_read_b64_tr_b16 v[70:71], v115 offset:1024
    s_waitcnt lgkmcnt(4)
    v_mfma_f32_32x32x16_bf16 v[192:207], v[72:75], v[32:35], v[192:207]
    ds_read_b32 v60, v125
    s_waitcnt vmcnt(12)
    v_xor_b32 v40, v40, v112
    v_xor_b32 v42, v42, v113
    v_xor_b32 v44, v44, v112
    v_xor_b32 v46, v46, v113
    v_mfma_f32_32x32x16_bf16 v[208:223], v[72:75], v[36:39], v[208:223]
    v_or3_b32 v56, v40, v42, v44
    v_or_b32 v56, v56, v46
    v_and_b32 v56, 0x80008000, v56
    v_cmp_ne_u32 vcc, 0, v56
    ds_read_b64_tr_b16 v[72:73], v114 offset:2048
    ds_read_b64_tr_b16 v[74:75], v114 offset:3072
    v_mfma_f32_32x32x16_bf16 v[224:239], v[76:79], v[32:35], v[224:239]
    s_cbranch_vccnz kf_kernel_hr14
kf_kernel_hk14:
    s_add_u32 s43, s46, 4096
    buffer_load_dwordx4 v[32:35], v9, s[64:67], s43 offen offset:2048 sc1
    v_mfma_f32_32x32x16_bf16 v[240:255], v[76:79], v[36:39], v[240:255]
    buffer_load_dwordx4 v[36:39], v9, s[64:67], s43 offen offset:3072 sc1
    ds_read_b64_tr_b16 v[76:77], v115 offset:2048
    ds_read_b64_tr_b16 v[78:79], v115 offset:3072
    s_waitcnt lgkmcnt(4)
    v_cmp_gt_u32 vcc, 6, v60
    s_cbranch_vccnz kf_kernel_c14s
kf_kernel_c14b:
    v_mfma_f32_32x32x16_bf16 v[192:207], v[64:67], v[40:43], v[192:207]
    s_waitcnt vmcnt(12)
    v_xor_b32 v48, v48, v112
    v_xor_b32 v50, v50, v113
    v_xor_b32 v52, v52, v112
    v_xor_b32 v54, v54, v113
    v_mfma_f32_32x32x16_bf16 v[208:223], v[64:67], v[44:47], v[208:223]
    v_or3_b32 v56, v48, v50, v52
    v_or_b32 v56, v56, v54
    v_and_b32 v56, 0x80008000, v56
    v_cmp_ne_u32 vcc, 0, v56
    ds_read_b64_tr_b16 v[64:65], v116 offset:0
    ds_read_b64_tr_b16 v[66:67], v116 offset:1024
    v_mfma_f32_32x32x16_bf16 v[224:239], v[68:71], v[40:43], v[224:239]
    s_cbranch_vccnz kf_kernel_hr15
kf_kernel_hk15:
    s_add_u32 s43, s46, 12288
    buffer_load_dwordx4 v[40:43], v9, s[64:67], s43 offen offset:2048 sc1
    ds_read_b64_tr_b16 v[144:145], v114 offset:4096
    ds_read_b64_tr_b16 v[146:147], v114 offset:5120
    ds_read_b64_tr_b16 v[148:149], v115 offset:4096
    v_mfma_f32_32x32x16_bf16 v[240:255], v[68:71], v[44:47], v[240:255]
    buffer_load_dwordx4 v[44:47], v9, s[64:67], s43 offen offset:3072 sc1
    ds_read_b64_tr_b16 v[68:69], v117 offset:0
    ds_read_b64_tr_b16 v[70:71], v117 offset:1024
    s_waitcnt lgkmcnt(7)
    v_mfma_f32_32x32x16_bf16 v[192:207], v[72:75], v[48:51], v[192:207]
    s_waitcnt vmcnt(12)
    v_xor_b32 v80, v80, v112
    v_xor_b32 v82, v82, v113
    v_xor_b32 v84, v84, v112
    v_xor_b32 v86, v86, v113
    v_mfma_f32_32x32x16_bf16 v[208:223], v[72:75], v[52:55], v[208:223]
    v_or3_b32 v56, v80, v82, v84
    v_or_b32 v56, v56, v86
    v_and_b32 v56, 0x80008000, v56
    v_cmp_ne_u32 vcc, 0, v56
    ds_read_b64_tr_b16 v[72:73], v116 offset:2048
    ds_read_b64_tr_b16 v[74:75], v116 offset:3072
    v_mfma_f32_32x32x16_bf16 v[224:239], v[76:79], v[48:51], v[224:239]
    s_cbranch_vccnz kf_kernel_hr16
kf_kernel_hk16:
    s_add_u32 s43, s46, 20480
    buffer_load_dwordx4 v[48:51], v9, s[64:67], s43 offen offset:2048 sc1
    ds_read_b64_tr_b16 v[150:151], v115 offset:5120
    ds_read_b64_tr_b16 v[152:153], v114 offset:6144
    ds_read_b64_tr_b16 v[154:155], v114 offset:7168
    v_mfma_f32_32x32x16_bf16 v[240:255], v[76:79], v[52:55], v[240:255]
    buffer_load_dwordx4 v[52:55], v9, s[64:67], s43 offen offset:3072 sc1
    ds_read_b64_tr_b16 v[76:77], v117 offset:2048
    ds_read_b64_tr_b16 v[78:79], v117 offset:3072
    s_waitcnt lgkmcnt(7)
    v_mfma_f32_32x32x16_bf16 v[192:207], v[64:67], v[80:83], v[192:207]
    s_waitcnt vmcnt(12)
    v_xor_b32 v88, v88, v112
    v_xor_b32 v90, v90, v113
    v_xor_b32 v92, v92, v112
    v_xor_b32 v94, v94, v113
    v_mfma_f32_32x32x16_bf16 v[208:223], v[64:67], v[84:87], v[208:223]
    v_or3_b32 v56, v88, v90, v92
    v_or_b32 v56, v56, v94
    v_and_b32 v56, 0x80008000, v56
    v_cmp_ne_u32 vcc, 0, v56
    ds_read_b64_tr_b16 v[64:65], v120 offset:4096
    ds_read_b64_tr_b16 v[66:67], v120 offset:5120
    v_mfma_f32_32x32x16_bf16 v[224:239], v[68:71], v[80:83], v[224:239]
    s_cbranch_vccnz kf_kernel_hr17
kf_kernel_hk17:
    s_add_u32 s42, s45, 20480
    buffer_load_dwordx4 v[80:83], v9, s[64:67], s42 offen offset:0 sc1
    ds_read_b64_tr_b16 v[156:157], v115 offset:6144
    ds_read_b64_tr_b16 v[158:159], v115 offset:7168
    ds_read_b64_tr_b16 v[160:161], v116 offset:4096
    v_mfma_f32_32x32x16_bf16 v[240:255], v[68:71], v[84:87], v[240:255]
    buffer_load_dwordx4 v[84:87], v9, s[64:67], s42 offen offset:1024 sc1
    ds_read_b64_tr_b16 v[68:69], v121 offset:4096
    ds_read_b64_tr_b16 v[70:71], v121 offset:5120
    s_waitcnt lgkmcnt(7)
    v_mfma_f32_32x32x16_bf16 v[192:207], v[72:75], v[88:91], v[192:207]
    ds_read_b32 v60, v125
    s_waitcnt vmcnt(12)
    v_xor_b32 v96, v96, v112
    v_xor_b32 v98, v98, v113
    v_xor_b32 v100, v100, v112
    v_xor_b32 v102, v102, v113
    v_mfma_f32_32x32x16_bf16 v[208:223], v[72:75], v[92:95], v[208:223]
    v_or3_b32 v56, v96, v98, v100
    v_or_b32 v56, v56, v102
    v_and_b32 v56, 0x80008000, v56
    v_cmp_ne_u32 vcc, 0, v56
    ds_read_b64_tr_b16 v[72:73], v120 offset:6144
    ds_read_b64_tr_b16 v[74:75], v120 offset:7168
    v_mfma_f32_32x32x16_bf16 v[224:239], v[76:79], v[88:91], v[224:239]
    s_cbranch_vccnz kf_kernel_hr18
kf_kernel_hk18:
    s_add_u32 s42, s45, 4096
    buffer_load_dwordx4 v[88:91], v9, s[64:67], s42 offen offset:2048 sc1
    v_add_u32 v4, s53, v9
    v_add_u32 v5, s50, v9
    ds_read_b64_tr_b16 v[162:163], v116 offset:5120
    ds_read_b64_tr_b16 v[164:165], v117 offset:4096
    ds_read_b64_tr_b16 v[166:167], v117 offset:5120
    v_mfma_f32_32x32x16_bf16 v[240:255], v[76:79], v[92:95], v[240:255]
    buffer_load_dwordx4 v[92:95], v9, s[64:67], s42 offen offset:3072 sc1
    ds_read_b64_tr_b16 v[76:77], v121 offset:6144
    ds_read_b64_tr_b16 v[78:79], v121 offset:7168
    s_waitcnt lgkmcnt(7)
    v_cmp_gt_u32 vcc, 7, v60
    s_cbranch_vccnz kf_kernel_c18s
kf_kernel_c18b:
    v_mfma_f32_32x32x16_bf16 v[192:207], v[64:67], v[96:99], v[192:207]
    s_waitcnt vmcnt(12)
    v_xor_b32 v104, v104, v112
    v_xor_b32 v106, v106, v113
    v_xor_b32 v108, v108, v112
    v_xor_b32 v110, v110, v113
    v_mfma_f32_32x32x16_bf16 v[208:223], v[64:67], v[100:103], v[208:223]
    v_or3_b32 v56, v104, v106, v108
    v_or_b32 v56, v56, v110
    v_and_b32 v56, 0x80008000, v56
    v_cmp_ne_u32 vcc, 0, v56
    ds_read_b64_tr_b16 v[128:129], v118 offset:0
    ds_read_b64_tr_b16 v[130:131], v118 offset:1024
    v_mfma_f32_32x32x16_bf16 v[224:239], v[68:71], v[96:99], v[224:239]
    s_cbranch_vccnz kf_kernel_hr19
kf_kernel_hk19:
    s_add_u32 s42, s45, 12288
    buffer_load_dwordx4 v[96:99], v9, s[64:67], s42 offen offset:2048 sc1
    ds_read_b64_tr_b16 v[168:169], v116 offset:6144
    ds_read_b64_tr_b16 v[170:171], v116 offset:7168
    v_mfma_f32_32x32x16_bf16 v[240:255], v[68:71], v[100:103], v[240:255]
    buffer_load_dwordx4 v[100:103], v9, s[64:67], s42 offen offset:3072 sc1
    ds_read_b64_tr_b16 v[132:133], v119 offset:0
    ds_read_b64_tr_b16 v[134:135], v119 offset:1024
    s_waitcnt lgkmcnt(6)
    v_mfma_f32_32x32x16_bf16 v[192:207], v[72:75], v[104:107], v[192:207]
    s_waitcnt vmcnt(12)
    v_xor_b32 v24, v24, v112
    v_xor_b32 v26, v26, v113
    v_xor_b32 v28, v28, v112
    v_xor_b32 v30, v30, v113
    v_mfma_f32_32x32x16_bf16 v[208:223], v[72:75], v[108:111], v[208:223]
    v_or3_b32 v56, v24, v26, v28
    v_or_b32 v56, v56, v30
    v_and_b32 v56, 0x80008000, v56
    v_cmp_ne_u32 vcc, 0, v56
    ds_read_b64_tr_b16 v[136:137], v118 offset:2048
    ds_read_b64_tr_b16 v[138:139], v118 offset:3072
    v_mfma_f32_32x32x16_bf16 v[224:239], v[76:79], v[104:107], v[224:239]
    s_cbranch_vccnz kf_kernel_hr20x
kf_kernel_hk20x:
    s_add_u32 s42, s45, 20480
    buffer_load_dwordx4 v[104:107], v9, s[64:67], s42 offen offset:2048 sc1
    ds_read_b64_tr_b16 v[172:173], v117 offset:6144
    ds_read_b64_tr_b16 v[174:175], v117 offset:7168
    v_mfma_f32_32x32x16_bf16 v[240:255], v[76:79], v[108:111], v[240:255]
    buffer_load_dwordx4 v[108:111], v9, s[64:67], s42 offen offset:3072 sc1
    ds_read_b64_tr_b16 v[140:141], v119 offset:2048
    ds_read_b64_tr_b16 v[142:143], v119 offset:3072
    s_waitcnt lgkmcnt(6)
    v_mfma_f32_32x32x16_bf16 v[240:255], v[132:135], v[24:27], v[240:255]
    s_waitcnt vmcnt(12)
    v_xor_b32 v32, v32, v112
    v_xor_b32 v34, v34, v113
    v_xor_b32 v36, v36, v112
    v_xor_b32 v38, v38, v113
    v_mfma_f32_32x32x16_bf16 v[208:223], v[128:131], v[24:27], v[208:223]
    v_or3_b32 v56, v32, v34, v36
    v_or_b32 v56, v56, v38
    v_and_b32 v56, 0x80008000, v56
    v_cmp_ne_u32 vcc, 0, v56
    s_waitcnt lgkmcnt(0)
    v_mfma_f32_32x32x16_bf16 v[240:255], v[140:143], v[28:31], v[240:255]
    s_cbranch_vccnz kf_kernel_hr22x
kf_kernel_hk22x:
    ds_read_b64_tr_b16 v[176:177], v118 offset:4096
    v_mfma_f32_32x32x16_bf16 v[208:223], v[136:139], v[28:31], v[208:223]
    ds_read_b64_tr_b16 v[178:179], v118 offset:5120
    ds_read_b64_tr_b16 v[180:181], v119 offset:4096
    ds_read_b64_tr_b16 v[182:183], v119 offset:5120
    v_mfma_f32_32x32x16_bf16 v[240:255], v[148:151], v[32:35], v[240:255]
    s_waitcnt vmcnt(10)
    v_xor_b32 v40, v40, v112
    v_xor_b32 v42, v42, v113
    v_xor_b32 v44, v44, v112
    v_xor_b32 v46, v46, v113
    v_mfma_f32_32x32x16_bf16 v[208:223], v[144:147], v[32:35], v[208:223]
    v_or3_b32 v56, v40, v42, v44
    v_or_b32 v56, v56, v46
    v_and_b32 v56, 0x80008000, v56
    v_cmp_ne_u32 vcc, 0, v56
    v_mfma_f32_32x32x16_bf16 v[240:255], v[156:159], v[36:39], v[240:255]
    s_cbranch_vccnz kf_kernel_hr24x
kf_kernel_hk24x:
    ds_read_b64_tr_b16 v[184:185], v118 offset:6144
    ds_read_b64_tr_b16 v[186:187], v118 offset:7168
    ds_read_b64_tr_b16 v[188:189], v119 offset:6144
    v_mfma_f32_32x32x16_bf16 v[208:223], v[152:155], v[36:39], v[208:223]
    ds_read_b64_tr_b16 v[190:191], v119 offset:7168
    ds_read_b128 v[60:63], v126 offset:48
    v_mfma_f32_32x32x16_bf16 v[240:255], v[164:167], v[40:43], v[240:255]
    s_waitcnt vmcnt(8)
    v_xor_b32 v48, v48, v112
    v_xor_b32 v50, v50, v113
    v_xor_b32 v52, v52, v112
    v_xor_b32 v54, v54, v113
    v_mfma_f32_32x32x16_bf16 v[208:223], v[160:163], v[40:43], v[208:223]
    v_or3_b32 v56, v48, v50, v52
    v_or_b32 v56, v56, v54
    v_and_b32 v56, 0x80008000, v56
    v_cmp_ne_u32 vcc, 0, v56
    v_mfma_f32_32x32x16_bf16 v[240:255], v[172:175], v[44:47], v[240:255]
    s_cbranch_vccnz kf_kernel_hr26x
kf_kernel_hk26x:
    s_waitcnt lgkmcnt(0)
    v_min_u32 v60, v60, v61
    v_min3_u32 v60, v60, v62, v63
    v_cmp_gt_u32 vcc, 8, v60
    s_cbranch_vccnz kf_kernel_cxs
kf_kernel_cxb:
    v_mfma_f32_32x32x16_bf16 v[208:223], v[168:171], v[44:47], v[208:223]
    ds_read_b64_tr_b16 v[16:17], v123 offset:0
    ds_read_b64_tr_b16 v[18:19], v123 offset:1024
    ds_read_b64_tr_b16 v[20:21], v123 offset:2048
    ds_read_b64_tr_b16 v[22:23], v123 offset:3072
    ds_read_b32 v58, v124
    v_mfma_f32_32x32x16_bf16 v[240:255], v[180:183], v[48:51], v[240:255]
    s_waitcnt vmcnt(6)
    v_xor_b32 v80, v80, v112
    v_xor_b32 v82, v82, v113
    v_xor_b32 v84, v84, v112
    v_xor_b32 v86, v86, v113
    v_mfma_f32_32x32x16_bf16 v[208:223], v[176:179], v[48:51], v[208:223]
    v_or3_b32 v56, v80, v82, v84
    v_or_b32 v56, v56, v86
    v_and_b32 v56, 0x80008000, v56
    v_cmp_ne_u32 vcc, 0, v56
    v_mfma_f32_32x32x16_bf16 v[240:255], v[188:191], v[52:55], v[240:255]
    s_cbranch_vccnz kf_kernel_hr20y
kf_kernel_hk20y:
    v_add_u32 v6, s55, v9
    v_add_u32 v7, s56, v9
    v_add_u32 v8, s57, v9
    s_waitcnt lgkmcnt(0)
    v_lshlrev_b32 v64, 16, v16
    v_and_b32 v65, 0xffff0000, v16
    v_mfma_f32_32x32x16_bf16 v[208:223], v[184:187], v[52:55], v[208:223]
    v_lshlrev_b32 v66, 16, v17
    v_and_b32 v67, 0xffff0000, v17
    v_lshlrev_b32 v68, 16, v18
    v_and_b32 v69, 0xffff0000, v18
    v_mfma_f32_32x32x16_bf16 v[224:239], v[132:135], v[80:83], v[224:239]
    s_waitcnt vmcnt(4)
    v_xor_b32 v88, v88, v112
    v_xor_b32 v90, v90, v113
    v_xor_b32 v92, v92, v112
    v_xor_b32 v94, v94, v113
    ds_write_b128 v5, v[240:243] offset:0
    v_mfma_f32_32x32x16_bf16 v[192:207], v[128:131], v[80:83], v[192:207]
    v_or3_b32 v56, v88, v90, v92
    v_or_b32 v56, v56, v94
    v_and_b32 v56, 0x80008000, v56
    v_cmp_ne_u32 vcc, 0, v56
    ds_write_b128 v4, v[208:211] offset:0
    v_mfma_f32_32x32x16_bf16 v[224:239], v[140:143], v[84:87], v[224:239]
    s_cbranch_vccnz kf_kernel_hr22y
kf_kernel_hk22y:
    ds_write_b128 v5, v[244:247] offset:1024
    v_mfma_f32_32x32x16_bf16 v[192:207], v[136:139], v[84:87], v[192:207]
    v_lshlrev_b32 v70, 16, v19
    v_and_b32 v71, 0xffff0000, v19
    ds_write_b128 v4, v[212:215] offset:1024
    v_mfma_f32_32x32x16_bf16 v[224:239], v[148:151], v[88:91], v[224:239]
    s_waitcnt vmcnt(2)
    v_xor_b32 v96, v96, v112
    v_xor_b32 v98, v98, v113
    v_xor_b32 v100, v100, v112
    v_xor_b32 v102, v102, v113
    ds_write_b128 v5, v[248:251] offset:2048
    v_mfma_f32_32x32x16_bf16 v[192:207], v[144:147], v[88:91], v[192:207]
    v_or3_b32 v56, v96, v98, v100
    v_or_b32 v56, v56, v102
    v_and_b32 v56, 0x80008000, v56
    v_cmp_ne_u32 vcc, 0, v56
    ds_write_b128 v4, v[216:219] offset:2048
    v_mfma_f32_32x32x16_bf16 v[224:239], v[156:159], v[92:95], v[224:239]
    s_cbranch_vccnz kf_kernel_hr24y
kf_kernel_hk24y:
    ds_write_b128 v5, v[252:255] offset:3072
    v_mfma_f32_32x32x16_bf16 v[192:207], v[152:155], v[92:95], v[192:207]
    v_lshlrev_b32 v72, 16, v20
    v_and_b32 v73, 0xffff0000, v20
    ds_write_b128 v4, v[220:223] offset:3072
    v_mfma_f32_32x32x16_bf16 v[224:239], v[164:167], v[96:99], v[224:239]
    s_waitcnt vmcnt(0)
    v_xor_b32 v104, v104, v112
    v_xor_b32 v106, v106, v113
    v_xor_b32 v108, v108, v112
    v_xor_b32 v110, v110, v113
    v_mfma_f32_32x32x16_bf16 v[224:239], v[172:175], v[100:103], v[224:239]
    v_or3_b32 v56, v104, v106, v108
    v_or_b32 v56, v56, v110
    v_and_b32 v56, 0x80008000, v56
    v_cmp_ne_u32 vcc, 0, v56
    s_cbranch_vccnz kf_kernel_hr26y
kf_kernel_hk26y:
    v_mfma_f32_32x32x16_bf16 v[224:239], v[180:183], v[104:107], v[224:239]
    v_lshlrev_b32 v74, 16, v21
    v_and_b32 v75, 0xffff0000, v21
    v_mfma_f32_32x32x16_bf16 v[224:239], v[188:191], v[108:111], v[224:239]
    v_lshlrev_b32 v76, 16, v22
    v_and_b32 v77, 0xffff0000, v22
    v_mfma_f32_32x32x16_bf16 v[192:207], v[160:163], v[96:99], v[192:207]
    v_lshlrev_b32 v78, 16, v23
    v_and_b32 v79, 0xffff0000, v23
    v_mfma_f32_32x32x16_bf16 v[192:207], v[168:171], v[100:103], v[192:207]
    ds_write_b128 v4, v[224:227] offset:4096
    ds_write_b128 v4, v[228:231] offset:5120
    v_mfma_f32_32x32x16_bf16 v[192:207], v[176:179], v[104:107], v[192:207]
    ds_write_b128 v4, v[232:235] offset:6144
    v_mfma_f32_32x32x16_bf16 v[192:207], v[184:187], v[108:111], v[192:207]
    ds_write_b128 v4, v[236:239] offset:7168
    s_waitcnt lgkmcnt(0)
    s_barrier
    ds_read_b128 v[160:163], v6 offset:0
    ds_read_b128 v[164:167], v6 offset:1024
    ds_read_b128 v[168:171], v6 offset:2048
    ds_read_b128 v[172:175], v6 offset:3072
    ds_read_b128 v[176:179], v7 offset:0
    ds_read_b128 v[180:183], v7 offset:1024
    ds_read_b128 v[184:187], v7 offset:2048
    ds_read_b128 v[188:191], v7 offset:3072
    ds_read_b128 v[80:83], v8 offset:0
    ds_read_b128 v[84:87], v8 offset:1024
    ds_read_b128 v[88:91], v8 offset:2048
    ds_read_b128 v[92:95], v8 offset:3072
    s_waitcnt lgkmcnt(11)
    v_pk_add_f32 v[192:193], v[192:193], v[160:161]
    v_pk_add_f32 v[194:195], v[194:195], v[162:163]
    s_waitcnt lgkmcnt(10)
    v_pk_add_f32 v[196:197], v[196:197], v[164:165]
    v_pk_add_f32 v[198:199], v[198:199], v[166:167]
    s_waitcnt lgkmcnt(9)
    v_pk_add_f32 v[200:201], v[200:201], v[168:169]
    v_pk_add_f32 v[202:203], v[202:203], v[170:171]
    s_waitcnt lgkmcnt(8)
    v_pk_add_f32 v[204:205], v[204:205], v[172:173]
    v_pk_add_f32 v[206:207], v[206:207], v[174:175]
    s_waitcnt lgkmcnt(7)
    v_pk_add_f32 v[192:193], v[192:193], v[176:177]
    v_pk_add_f32 v[194:195], v[194:195], v[178:179]
    s_waitcnt lgkmcnt(6)
    v_pk_add_f32 v[196:197], v[196:197], v[180:181]
    v_pk_add_f32 v[198:199], v[198:199], v[182:183]
    s_waitcnt lgkmcnt(5)
    v_pk_add_f32 v[200:201], v[200:201], v[184:185]
    v_pk_add_f32 v[202:203], v[202:203], v[186:187]
    s_waitcnt lgkmcnt(4)
    v_pk_add_f32 v[204:205], v[204:205], v[188:189]
    v_pk_add_f32 v[206:207], v[206:207], v[190:191]
    s_waitcnt lgkmcnt(3)
    v_pk_add_f32 v[192:193], v[192:193], v[80:81]
    v_pk_add_f32 v[194:195], v[194:195], v[82:83]
    s_waitcnt lgkmcnt(2)
    v_pk_add_f32 v[196:197], v[196:197], v[84:85]
    v_pk_add_f32 v[198:199], v[198:199], v[86:87]
    s_waitcnt lgkmcnt(1)
    v_pk_add_f32 v[200:201], v[200:201], v[88:89]
    v_pk_add_f32 v[202:203], v[202:203], v[90:91]
    s_waitcnt lgkmcnt(0)
    v_pk_add_f32 v[204:205], v[204:205], v[92:93]
    v_pk_add_f32 v[206:207], v[206:207], v[94:95]
    v_pk_fma_f32 v[64:65], v[192:193], v[58:59], v[64:65] op_sel:[0,0,0] op_sel_hi:[1,0,1]
    v_pk_fma_f32 v[66:67], v[194:195], v[58:59], v[66:67] op_sel:[0,0,0] op_sel_hi:[1,0,1]
    v_pk_fma_f32 v[68:69], v[196:197], v[58:59], v[68:69] op_sel:[0,0,0] op_sel_hi:[1,0,1]
    v_pk_fma_f32 v[70:71], v[198:199], v[58:59], v[70:71] op_sel:[0,0,0] op_sel_hi:[1,0,1]
    v_pk_fma_f32 v[72:73], v[200:201], v[58:59], v[72:73] op_sel:[0,0,0] op_sel_hi:[1,0,1]
    v_pk_fma_f32 v[74:75], v[202:203], v[58:59], v[74:75] op_sel:[0,0,0] op_sel_hi:[1,0,1]
    v_pk_fma_f32 v[76:77], v[204:205], v[58:59], v[76:77] op_sel:[0,0,0] op_sel_hi:[1,0,1]
    v_pk_fma_f32 v[78:79], v[206:207], v[58:59], v[78:79] op_sel:[0,0,0] op_sel_hi:[1,0,1]
    v_cvt_pk_bf16_f32 v16, v64, v65
    v_cvt_pk_bf16_f32 v17, v66, v67
    v_cvt_pk_bf16_f32 v18, v68, v69
    v_cvt_pk_bf16_f32 v19, v70, v71
    v_cvt_pk_bf16_f32 v20, v72, v73
    v_cvt_pk_bf16_f32 v21, v74, v75
    v_cvt_pk_bf16_f32 v22, v76, v77
    v_cvt_pk_bf16_f32 v23, v78, v79
    s_nop 1
    v_permlane32_swap_b32 v16, v18
    v_permlane32_swap_b32 v17, v19
    v_permlane32_swap_b32 v20, v22
    v_permlane32_swap_b32 v21, v23
    buffer_store_dwordx4 v[16:19], v122, s[68:71], s49 offen offset:0
    buffer_store_dwordx4 v[20:23], v122, s[68:71], s49 offen offset:32
    s_endpgm
kf_kernel_h3:
    v_lshlrev_b32 v53, 4, v3
    v_lshl_add_u32 v53, v2, 17, v53
    s_and_b32 s30, s2, 7
    s_lshl_b32 s32, s30, 5
    s_add_u32 s32, s32, s31
    v_lshrrev_b32 v17, 2, v1
    v_lshlrev_b32 v11, 14, v17
    v_lshl_add_u32 v11, v19, 4, v11
    s_lshl_b32 s40, s34, 20
    s_lshl_b32 s36, s32, 6
    v_and_b32 v18, 7, v17
    v_lshlrev_b32 v18, 7, v18
    v_xor_b32 v18, s36, v18
    v_add_u32 v11, v11, v18
    s_add_u32 s40, s40, 0x400000
    s_add_u32 s41, s40, 0x40000
    s_add_u32 s42, s40, 0x80000
    s_add_u32 s43, s40, 0xc0000
    v_lshlrev_b32 v12, 4, v1
    s_lshl_b32 s39, s34, 12
    s_add_u32 s39, s39, 0x1150000
    s_mul_i32 s36, s31, 37
    s_lshr_b32 s36, s36, 8
    s_mul_i32 s37, s36, 7
    s_sub_u32 s37, s31, s37
    s_lshr_b32 s38, s30, 1
    s_lshl_b32 s38, s38, 2
    s_add_u32 s6, s38, s36
    s_mov_b32 s4, 0
    s_lshl_b32 s8, s38, 1
    s_lshr_b32 s36, s31, 2
    s_add_u32 s8, s8, s36
    s_and_b32 s38, s30, 1
    s_mul_i32 s36, s38, 7
    s_add_u32 s7, s36, s37
    s_lshl_b32 s38, s38, 2
    s_and_b32 s36, s31, 3
    s_add_u32 s9, s38, s36
    s_lshr_b32 s37, s31, 2
    s_lshl_b32 s36, s36, 1
    s_add_u32 s36, s36, s37
    s_mov_b32 s5, 0
    s_mov_b32 s68, s24
    s_and_b32 s69, s25, 0xffff
    s_mov_b32 s70, 0x1c0000
    s_mov_b32 s71, 0x20000
    s_mov_b32 s72, s26
    s_and_b32 s73, s27, 0xffff
    s_mov_b32 s74, 0x1c0000
    s_mov_b32 s75, 0x20000
    v_lshrrev_b32 v2, 3, v1
    v_and_b32 v17, 7, v1
    v_lshrrev_b32 v3, 2, v1
    v_and_b32 v3, 4, v3
    v_xor_b32 v3, v3, v17
    v_lshlrev_b32 v4, 10, v2
    v_lshl_add_u32 v4, v3, 4, v4
    v_add_u32 v5, 7168, v4
    s_mul_i32 s10, s34, 458752
    s_lshl_b32 s37, s9, 7
    s_add_u32 s10, s10, s37
    s_and_b32 s37, s34, 1
    s_cselect_b32 s36, 0, 393216
    s_add_u32 s78, s10, s36
    s_lshl_b32 s37, s37, 16
    s_add_u32 s10, s10, s37
    s_mov_b64 s[44:45], -1
    s_mov_b64 s[46:47], -1
    s_mov_b64 s[48:49], -1
    s_mov_b64 s[50:51], -1
    s_mov_b64 s[52:53], -1
    s_mov_b64 s[54:55], -1
    s_mov_b64 s[56:57], -1
    s_mov_b64 s[58:59], -1
    s_mov_b32 s76, 0
    s_mov_b32 s77, 0
    s_add_u32 s11, s10, 327680
    buffer_load_dwordx4 v[224:227], v4, s[72:75], s11 offen
    buffer_load_dwordx4 v[228:231], v5, s[72:75], s11 offen offset:1024
    s_add_u32 s11, s10, 344064
    buffer_load_dwordx4 v[232:235], v4, s[72:75], s11 offen
    buffer_load_dwordx4 v[236:239], v5, s[72:75], s11 offen offset:1024
    s_add_u32 s11, s10, 360448
    buffer_load_dwordx4 v[240:243], v4, s[72:75], s11 offen
    buffer_load_dwordx4 v[244:247], v5, s[72:75], s11 offen offset:1024
    s_add_u32 s11, s10, 376832
    buffer_load_dwordx4 v[248:251], v4, s[72:75], s11 offen
    buffer_load_dwordx4 v[252:255], v5, s[72:75], s11 offen offset:1024
    s_mov_b64 exec, 0
    s_branch kf_kernel_ok
kf_kernel_dry:
    s_mov_b64 exec, -1
    s_waitcnt vmcnt(8)
    s_sleep 10
    buffer_load_dwordx4 v[112:115], v11, s[64:67], s40 offen sc1
    buffer_load_dwordx4 v[116:119], v11, s[64:67], s41 offen sc1
    buffer_load_dwordx4 v[120:123], v11, s[64:67], s42 offen sc1
    buffer_load_dwordx4 v[124:127], v11, s[64:67], s43 offen sc1
    buffer_load_dwordx4 v[128:131], v12, s[64:67], s39 offen offset:0 sc1
    buffer_load_dwordx4 v[132:135], v12, s[64:67], s39 offen offset:1024 sc1
    buffer_load_dwordx4 v[136:139], v12, s[64:67], s39 offen offset:2048 sc1
    buffer_load_dwordx4 v[140:143], v12, s[64:67], s39 offen offset:3072 sc1
    v_lshrrev_b32 v17, 2, v1
    v_bfe_u32 v18, v1, 1, 1
    v_and_b32 v19, 1, v1
    v_mul_u32_u24 v13, 4672, v18
    v_lshl_add_u32 v13, v17, 4, v13
    v_lshl_add_u32 v13, v19, 3, v13
    s_lshl_b32 s36, s34, 10
    s_add_u32 s36, s36, 98816
    v_add_u32 v13, s36, v13
    v_mul_u32_u24 v14, 8768, v18
    v_mul_u32_u24 v19, 272, v19
    v_add_u32 v14, v14, v19
    v_lshrrev_b32 v18, 3, v1
    v_lshl_add_u32 v14, v18, 4, v14
    v_bfe_u32 v18, v1, 2, 1
    v_mul_u32_u24 v18, 544, v18
    v_add_u32 v14, v14, v18
    s_add_u32 s36, s34, 1
    s_bfe_u32 s36, s36, 0x10001
    s_mul_i32 s36, s36, 4384
    s_lshr_b32 s38, s34, 1
    s_mul_i32 s38, s38, 2176
    s_add_u32 s36, s36, s38
    s_add_u32 s36, s36, 124352
    v_add_u32 v14, s36, v14
    v_mov_b32 v20, 0
    v_mov_b32 v21, 0
    v_mov_b32 v22, 0
    v_mov_b32 v23, 0
    s_lshr_b32 s36, s34, 1
    s_mul_i32 s36, s36, 4160
    s_lshl_b32 s38, s34, 8
    s_add_u32 s36, s36, s38
    s_add_u32 s36, s36, 98304
    v_add_u32 v17, s36, v12
    s_mul_i32 s36, s34, 4160
    s_add_u32 s36, s36, 111808
    v_add_u32 v18, s36, v12
    s_lshr_b32 s36, s34, 1
    s_mul_i32 s36, s36, 8320
    s_add_u32 s36, s36, 111806
    v_mov_b32 v19, s36
    s_mov_b64 exec, 0xffff
    ds_write_b128 v17, v[20:23]
    s_mov_b64 exec, -1
    v_mul_u32_u24 v6, 3584, v2
    v_lshl_add_u32 v6, v3, 4, v6
    s_mul_i32 s35, s34, 57344
    s_lshl_b32 s36, s7, 8
    s_add_u32 s35, s35, s36
    v_add_u32 v6, s35, v6
    v_add_u32 v7, 27648, v6
    s_lshl_b32 s15, s34, 11
    v_mov_b64 v[56:57], -1
    v_mov_b64 v[58:59], -1
    s_lshl_b32 s24, s34, 19
    s_lshl_b32 s25, s32, 9
    s_add_u32 s24, s24, s25
    s_add_u32 s24, s24, 0x800000
    s_add_u32 s25, s24, 262144
    s_mul_i32 s26, s34, 1792
    s_add_u32 s26, s26, 0
    v_lshl_add_u32 v50, v1, 4, s26
    v_and_b32 v52, 0xfffffe00, v50
    v_add_u32 v50, v50, v52
    s_mul_i32 s26, s34, 1792
    s_add_u32 s26, s26, 896
    v_lshl_add_u32 v51, v1, 4, s26
    v_and_b32 v52, 0xfffffe00, v51
    v_add_u32 v51, v51, v52
    s_mul_i32 s26, s31, 14336
    s_and_b32 s27, s30, 1
    s_lshl_b32 s27, s27, 9
    s_add_u32 s26, s26, s27
kf_kernel_chk:
    s_waitcnt vmcnt(7)
    v_cmp_ne_u32 s[44:45], v16, v114
    s_waitcnt vmcnt(6)
    v_cmp_ne_u32 s[46:47], v16, v118
    s_waitcnt vmcnt(5)
    v_cmp_ne_u32 s[48:49], v16, v122
    s_waitcnt vmcnt(4)
    v_cmp_ne_u32 s[50:51], v16, v126
    v_lshlrev_b32 v64, 16, v112
    v_and_b32 v65, 0xffff0000, v112
    v_lshlrev_b32 v66, 16, v113
    v_and_b32 v67, 0xffff0000, v113
    v_lshlrev_b32 v68, 16, v116
    v_and_b32 v69, 0xffff0000, v116
    v_lshlrev_b32 v70, 16, v117
    v_and_b32 v71, 0xffff0000, v117
    v_lshlrev_b32 v72, 16, v120
    v_and_b32 v73, 0xffff0000, v120
    v_lshlrev_b32 v74, 16, v121
    v_and_b32 v75, 0xffff0000, v121
    v_lshlrev_b32 v76, 16, v124
    v_and_b32 v77, 0xffff0000, v124
    v_lshlrev_b32 v78, 16, v125
    v_and_b32 v79, 0xffff0000, v125
    s_waitcnt vmcnt(3)
    v_cmp_ne_u32 s[52:53], v16, v130
    s_waitcnt vmcnt(2)
    v_cmp_ne_u32 s[54:55], v16, v134
    s_waitcnt vmcnt(1)
    v_cmp_ne_u32 s[56:57], v16, v138
    s_waitcnt vmcnt(0)
    v_cmp_ne_u32 s[58:59], v16, v142
    s_add_u32 s76, s76, 1
    s_or_b64 s[60:61], s[44:45], s[46:47]
    s_or_b64 s[62:63], s[48:49], s[50:51]
    s_or_b64 s[60:61], s[60:61], s[52:53]
    s_or_b64 s[62:63], s[62:63], s[54:55]
    s_or_b64 s[60:61], s[60:61], s[56:57]
    s_or_b64 s[62:63], s[62:63], s[58:59]
    s_or_b64 s[60:61], s[60:61], s[62:63]
    s_cbranch_scc1 kf_kernel_again
kf_kernel_okp:
    s_setprio 2
kf_kernel_ok:
    v_lshlrev_b32 v144, 16, v128
    v_lshlrev_b32 v145, 16, v129
    v_lshlrev_b32 v148, 16, v132
    v_lshlrev_b32 v149, 16, v133
    v_lshlrev_b32 v152, 16, v136
    v_lshlrev_b32 v153, 16, v137
    v_lshlrev_b32 v156, 16, v140
    v_lshlrev_b32 v157, 16, v141
    v_rcp_f32 v144, v144
    v_and_b32 v146, 0xffff0000, v128
    v_rcp_f32 v145, v145
    v_and_b32 v147, 0xffff0000, v129
    v_rcp_f32 v148, v148
    v_and_b32 v150, 0xffff0000, v132
    v_rcp_f32 v149, v149
    v_and_b32 v151, 0xffff0000, v133
    v_rcp_f32 v152, v152
    v_and_b32 v154, 0xffff0000, v136
    v_rcp_f32 v153, v153
    v_and_b32 v155, 0xffff0000, v137
    v_rcp_f32 v156, v156
    v_and_b32 v158, 0xffff0000, v140
    v_rcp_f32 v157, v157
    v_and_b32 v159, 0xffff0000, v141
    v_mul_f32 v146, -v146, v144
    v_mul_f32 v147, -v147, v145
    v_mul_f32 v150, -v150, v148
    v_mul_f32 v151, -v151, v149
    v_mul_f32 v154, -v154, v152
    v_mul_f32 v155, -v155, v153
    v_mul_f32 v158, -v158, v156
    v_mul_f32 v159, -v159, v157
    v_mov_b32_dpp v128, v146 quad_perm:[0,2,0,2] row_mask:0xf bank_mask:0xf
    v_mov_b32_dpp v129, v147 quad_perm:[0,2,0,2] row_mask:0xf bank_mask:0xf
    v_mov_b32_dpp v130, v146 quad_perm:[1,3,1,3] row_mask:0xf bank_mask:0xf
    v_mov_b32_dpp v131, v147 quad_perm:[1,3,1,3] row_mask:0xf bank_mask:0xf
    v_fmac_f32_dpp v128, v144, v64 quad_perm:[0,2,0,2] row_mask:0xf bank_mask:0xf
    v_fmac_f32_dpp v129, v145, v65 quad_perm:[0,2,0,2] row_mask:0xf bank_mask:0xf
    v_fmac_f32_dpp v130, v144, v66 quad_perm:[1,3,1,3] row_mask:0xf bank_mask:0xf
    v_fmac_f32_dpp v131, v145, v67 quad_perm:[1,3,1,3] row_mask:0xf bank_mask:0xf
    v_cvt_pk_bf16_f32 v80, v128, v129
    v_cvt_pk_bf16_f32 v81, v130, v131
    ds_write_b64 v13, v[80:81] offset:0
    v_mov_b32_dpp v132, v150 quad_perm:[0,2,0,2] row_mask:0xf bank_mask:0xf
    v_mov_b32_dpp v133, v151 quad_perm:[0,2,0,2] row_mask:0xf bank_mask:0xf
    v_mov_b32_dpp v134, v150 quad_perm:[1,3,1,3] row_mask:0xf bank_mask:0xf
    v_mov_b32_dpp v135, v151 quad_perm:[1,3,1,3] row_mask:0xf bank_mask:0xf
    v_fmac_f32_dpp v132, v148, v68 quad_perm:[0,2,0,2] row_mask:0xf bank_mask:0xf
    v_fmac_f32_dpp v133, v149, v69 quad_perm:[0,2,0,2] row_mask:0xf bank_mask:0xf
    v_fmac_f32_dpp v134, v148, v70 quad_perm:[1,3,1,3] row_mask:0xf bank_mask:0xf
    v_fmac_f32_dpp v135, v149, v71 quad_perm:[1,3,1,3] row_mask:0xf bank_mask:0xf
    v_cvt_pk_bf16_f32 v82, v132, v133
    v_cvt_pk_bf16_f32 v83, v134, v135
    ds_write_b64 v13, v[82:83] offset:256
    v_mov_b32_dpp v136, v154 quad_perm:[0,2,0,2] row_mask:0xf bank_mask:0xf
    v_mov_b32_dpp v137, v155 quad_perm:[0,2,0,2] row_mask:0xf bank_mask:0xf
    v_mov_b32_dpp v138, v154 quad_perm:[1,3,1,3] row_mask:0xf bank_mask:0xf
    v_mov_b32_dpp v139, v155 quad_perm:[1,3,1,3] row_mask:0xf bank_mask:0xf
    v_fmac_f32_dpp v136, v152, v72 quad_perm:[0,2,0,2] row_mask:0xf bank_mask:0xf
    v_fmac_f32_dpp v137, v153, v73 quad_perm:[0,2,0,2] row_mask:0xf bank_mask:0xf
    v_fmac_f32_dpp v138, v152, v74 quad_perm:[1,3,1,3] row_mask:0xf bank_mask:0xf
    v_fmac_f32_dpp v139, v153, v75 quad_perm:[1,3,1,3] row_mask:0xf bank_mask:0xf
    v_cvt_pk_bf16_f32 v84, v136, v137
    v_cvt_pk_bf16_f32 v85, v138, v139
    ds_write_b64 v13, v[84:85] offset:512
    v_mov_b32_dpp v140, v158 quad_perm:[0,2,0,2] row_mask:0xf bank_mask:0xf
    v_mov_b32_dpp v141, v159 quad_perm:[0,2,0,2] row_mask:0xf bank_mask:0xf
    v_mov_b32_dpp v142, v158 quad_perm:[1,3,1,3] row_mask:0xf bank_mask:0xf
    v_mov_b32_dpp v143, v159 quad_perm:[1,3,1,3] row_mask:0xf bank_mask:0xf
    v_fmac_f32_dpp v140, v156, v76 quad_perm:[0,2,0,2] row_mask:0xf bank_mask:0xf
    v_fmac_f32_dpp v141, v157, v77 quad_perm:[0,2,0,2] row_mask:0xf bank_mask:0xf
    v_fmac_f32_dpp v142, v156, v78 quad_perm:[1,3,1,3] row_mask:0xf bank_mask:0xf
    v_fmac_f32_dpp v143, v157, v79 quad_perm:[1,3,1,3] row_mask:0xf bank_mask:0xf
    v_cvt_pk_bf16_f32 v86, v140, v141
    v_cvt_pk_bf16_f32 v87, v142, v143
    ds_write_b64 v13, v[86:87] offset:768
    s_setprio 0
    s_cbranch_execz kf_kernel_dry
    s_waitcnt lgkmcnt(0)
    s_barrier
    s_setprio 0
    buffer_store_dwordx4 v[56:59], v53, s[64:67], s24 offen sc1
    buffer_store_dwordx4 v[56:59], v53, s[64:67], s25 offen sc1
    s_cmp_ge_u32 s2, 224
    s_cbranch_scc1 kf_kernel_na0
    s_add_u32 m0, s15, 0
    s_add_u32 s11, s4, 0
    s_and_b32 s11, s11, 7
    s_mul_i32 s11, s11, 229376
    buffer_load_dwordx4 v6, s[68:71], s11 offen lds
    buffer_load_dwordx4 v7, s[68:71], s11 offen offset:1024 lds
    s_add_u32 m0, s15, 8192
    s_add_u32 s11, s4, 1
    s_and_b32 s11, s11, 7
    s_mul_i32 s11, s11, 229376
    buffer_load_dwordx4 v6, s[68:71], s11 offen lds
    buffer_load_dwordx4 v7, s[68:71], s11 offen offset:1024 lds
kf_kernel_na0:
    ds_write_b128 v14, v[64:67] offset:0
    ds_write_b128 v14, v[68:71] offset:128
    ds_write_b128 v14, v[72:75] offset:1088
    ds_write_b128 v14, v[76:79] offset:1216
    s_cmp_ge_u32 s2, 224
    s_cbranch_scc1 kf_kernel_na3
    s_add_u32 m0, s15, 16384
    s_add_u32 s11, s4, 2
    s_and_b32 s11, s11, 7
    s_mul_i32 s11, s11, 229376
    buffer_load_dwordx4 v6, s[68:71], s11 offen lds
    buffer_load_dwordx4 v7, s[68:71], s11 offen offset:1024 lds
    s_add_u32 m0, s15, 24576
    s_add_u32 s11, s4, 3
    s_and_b32 s11, s11, 7
    s_mul_i32 s11, s11, 229376
    buffer_load_dwordx4 v6, s[68:71], s11 offen lds
    buffer_load_dwordx4 v7, s[68:71], s11 offen offset:1024 lds
    s_add_u32 m0, s15, 32768
    s_add_u32 s11, s4, 4
    s_and_b32 s11, s11, 7
    s_mul_i32 s11, s11, 229376
    buffer_load_dwordx4 v6, s[68:71], s11 offen lds
    buffer_load_dwordx4 v7, s[68:71], s11 offen offset:1024 lds
    s_waitcnt vmcnt(10)
    s_branch kf_kernel_na2
kf_kernel_na3:
    s_waitcnt vmcnt(0)
kf_kernel_na2:
    v_mov_b32 v26, 2
    s_waitcnt lgkmcnt(0)
    ds_write_b32 v15, v26
    s_add_u32 s36, s2, s34
    s_cmp_lg_u32 s36, 0
    s_cbranch_scc1 kf_kernel_nb
    s_mov_b64 exec, 1
    v_mov_b32 v20, 0x1140000
    global_store_dword v20, v16, s[28:29] sc1
    s_mov_b64 exec, -1
kf_kernel_nb:
    v_lshrrev_b32 v2, 3, v1
    v_and_b32 v18, 7, v1
    v_lshlrev_b32 v11, 8, v2
    v_lshl_add_u32 v11, v18, 4, v11
    v_add_u32 v13, 1024, v11
    s_mov_b32 exec_hi, 0x00ffffff
    s_lshr_b32 s27, s30, 1
    s_add_u32 s27, s27, 1
    s_and_b32 s27, s27, 3
    s_mul_i32 s27, s27, 458752
    s_add_u32 s27, s27, s26
    buffer_load_dwordx4 v[60:63], v50, s[72:75], s27 offen
    buffer_load_dwordx4 v[60:63], v51, s[72:75], s27 offen
    s_lshr_b32 s27, s30, 1
    s_add_u32 s27, s27, 2
    s_and_b32 s27, s27, 3
    s_mul_i32 s27, s27, 458752
    s_add_u32 s27, s27, s26
    buffer_load_dwordx4 v[60:63], v50, s[72:75], s27 offen
    buffer_load_dwordx4 v[60:63], v51, s[72:75], s27 offen
    s_lshr_b32 s27, s30, 1
    s_add_u32 s27, s27, 3
    s_and_b32 s27, s27, 3
    s_mul_i32 s27, s27, 458752
    s_add_u32 s27, s27, s26
    buffer_load_dwordx4 v[60:63], v50, s[72:75], s27 offen
    buffer_load_dwordx4 v[60:63], v51, s[72:75], s27 offen
    s_mov_b32 exec_hi, -1
    s_cmp_ge_u32 s2, 224
    s_cbranch_scc1 kf_kernel_na4
    s_add_u32 m0, s15, 40960
    s_add_u32 s11, s4, 5
    s_and_b32 s11, s11, 7
    s_mul_i32 s11, s11, 229376
    buffer_load_dwordx4 v6, s[68:71], s11 offen lds
    buffer_load_dwordx4 v7, s[68:71], s11 offen offset:1024 lds
    s_waitcnt vmcnt(8)
    s_add_u32 m0, s15, 49152
    s_add_u32 s11, s4, 6
    s_and_b32 s11, s11, 7
    s_mul_i32 s11, s11, 229376
    buffer_load_dwordx4 v6, s[68:71], s11 offen lds
    buffer_load_dwordx4 v7, s[68:71], s11 offen offset:1024 lds
    s_waitcnt vmcnt(8)
    s_add_u32 m0, s15, 57344
    s_add_u32 s11, s4, 7
    s_and_b32 s11, s11, 7
    s_mul_i32 s11, s11, 229376
    buffer_load_dwordx4 v6, s[68:71], s11 offen lds
    buffer_load_dwordx4 v7, s[68:71], s11 offen offset:1024 lds
    s_waitcnt vmcnt(8)
    s_add_u32 m0, s15, 65536
    s_add_u32 s11, s4, 0
    s_and_b32 s11, s11, 7
    s_mul_i32 s11, s11, 229376
    s_add_u32 s11, s11, 128
    buffer_load_dwordx4 v6, s[68:71], s11 offen lds
    buffer_load_dwordx4 v7, s[68:71], s11 offen offset:1024 lds
    s_waitcnt vmcnt(8)
    s_add_u32 m0, s15, 73728
    s_add_u32 s11, s4, 1
    s_and_b32 s11, s11, 7
    s_mul_i32 s11, s11, 229376
    s_add_u32 s11, s11, 128
    buffer_load_dwordx4 v6, s[68:71], s11 offen lds
    buffer_load_dwordx4 v7, s[68:71], s11 offen offset:1024 lds
    s_waitcnt vmcnt(8)
    s_add_u32 m0, s15, 81920
    s_add_u32 s11, s4, 2
    s_and_b32 s11, s11, 7
    s_mul_i32 s11, s11, 229376
    s_add_u32 s11, s11, 128
    buffer_load_dwordx4 v6, s[68:71], s11 offen lds
    buffer_load_dwordx4 v7, s[68:71], s11 offen offset:1024 lds
    s_waitcnt vmcnt(8)
    s_add_u32 m0, s15, 90112
    s_add_u32 s11, s4, 3
    s_and_b32 s11, s11, 7
    s_mul_i32 s11, s11, 229376
    s_add_u32 s11, s11, 128
    buffer_load_dwordx4 v6, s[68:71], s11 offen lds
    buffer_load_dwordx4 v7, s[68:71], s11 offen offset:1024 lds
    s_waitcnt vmcnt(8)
    s_branch kf_kernel_na1
kf_kernel_na4:
kf_kernel_na1:
    v_lshrrev_b32 v2, 4, v1
    v_lshlrev_b32 v2, 2, v2
    s_lshr_b32 s35, s34, 1
    s_lshl_b32 s35, s35, 4
    s_and_b32 s36, s34, 1
    s_lshl_b32 s36, s36, 1
    s_add_u32 s35, s35, s36
    v_add_u32 v2, s35, v2
    v_and_b32 v3, 15, v1
    v_lshlrev_b32 v3, 4, v3
    v_lshl_add_u32 v8, v2, 8, v3
    s_lshl_b32 s36, s6, 17
    v_add_u32 v8, s36, v8
    v_add_u32 v9, 256, v8
    s_lshl_b32 s33, s4, 1
    v_lshlrev_b32 v10, 4, v1
    s_lshl_b32 s35, s34, 10
    s_add_u32 s16, s35, 0x1160000
    s_mul_i32 s14, s34, 2176
    s_add_u32 s14, s14, 98304
    s_lshl_b32 s17, s34, 13
    s_lshr_b32 s35, s8, 1
    s_lshl_b32 s35, s35, 17
    s_and_b32 s37, s8, 1
    s_lshl_b32 s37, s37, 7
    s_add_u32 s35, s35, s37
    s_lshl_b32 s37, s9, 14
    s_add_u32 s35, s35, s37
    s_lshl_b32 s37, s34, 12
    s_add_u32 s35, s35, s37
    s_add_u32 s13, s35, 0x800000
    s_cmp_ge_u32 s7, 7
    s_cselect_b32 s35, 7, 0
    s_sub_u32 s35, s7, s35
    s_lshl_b32 s35, s35, 2
    s_add_u32 s35, s35, s34
    s_lshl_b32 s35, s35, 10
    s_lshl_b32 s36, s6, 17
    s_add_u32 s40, s35, s36
    s_add_u32 s40, s40, 0x800000
    s_add_u32 s42, s36, 0x81fc00
    s_add_u32 s11, s10, 262144
    buffer_load_dwordx4 v[96:99], v4, s[72:75], s11 offen
    buffer_load_dwordx4 v[100:103], v5, s[72:75], s11 offen offset:1024
    s_waitcnt vmcnt(8)
    s_add_u32 s11, s10, 278528
    buffer_load_dwordx4 v[104:107], v4, s[72:75], s11 offen
    buffer_load_dwordx4 v[108:111], v5, s[72:75], s11 offen offset:1024
    s_waitcnt vmcnt(8)
    s_add_u32 s11, s10, 294912
    buffer_load_dwordx4 v[112:115], v4, s[72:75], s11 offen
    buffer_load_dwordx4 v[116:119], v5, s[72:75], s11 offen offset:1024
    s_waitcnt vmcnt(8)
    s_add_u32 s11, s10, 311296
    buffer_load_dwordx4 v[120:123], v4, s[72:75], s11 offen
    buffer_load_dwordx4 v[124:127], v5, s[72:75], s11 offen offset:1024
    s_waitcnt vmcnt(8)
    v_mov_b32 v26, 1
    ds_write_b32 v15, v26 offset:32
    s_add_u32 s11, s78, 0
    buffer_load_dwordx4 v[128:131], v4, s[72:75], s11 offen
    buffer_load_dwordx4 v[132:135], v5, s[72:75], s11 offen offset:1024
    s_waitcnt vmcnt(8)
    s_add_u32 s11, s78, 16384
    buffer_load_dwordx4 v[136:139], v4, s[72:75], s11 offen
    buffer_load_dwordx4 v[140:143], v5, s[72:75], s11 offen offset:1024
    s_waitcnt vmcnt(8)
    s_add_u32 s11, s78, 32768
    buffer_load_dwordx4 v[144:147], v4, s[72:75], s11 offen
    buffer_load_dwordx4 v[148:151], v5, s[72:75], s11 offen offset:1024
    s_waitcnt vmcnt(8)
    s_add_u32 s11, s78, 49152
    buffer_load_dwordx4 v[152:155], v4, s[72:75], s11 offen
    buffer_load_dwordx4 v[156:159], v5, s[72:75], s11 offen offset:1024
    s_waitcnt vmcnt(8)
    s_add_u32 s11, s10, 65536
    buffer_load_dwordx4 v[160:163], v4, s[72:75], s11 offen
    buffer_load_dwordx4 v[164:167], v5, s[72:75], s11 offen offset:1024
    s_waitcnt vmcnt(8)
    s_add_u32 s11, s10, 81920
    buffer_load_dwordx4 v[168:171], v4, s[72:75], s11 offen
    buffer_load_dwordx4 v[172:175], v5, s[72:75], s11 offen offset:1024
    s_waitcnt vmcnt(8)
    s_add_u32 s11, s10, 98304
    buffer_load_dwordx4 v[176:179], v4, s[72:75], s11 offen
    buffer_load_dwordx4 v[180:183], v5, s[72:75], s11 offen offset:1024
    s_waitcnt vmcnt(8)
    s_add_u32 s11, s10, 114688
    buffer_load_dwordx4 v[184:187], v4, s[72:75], s11 offen
    buffer_load_dwordx4 v[188:191], v5, s[72:75], s11 offen offset:1024
    s_waitcnt vmcnt(8)
    v_not_b32 v19, v16
    s_cmp_ge_u32 s2, 224
    s_cselect_b32 exec_lo, 0, -1
    s_cselect_b32 exec_hi, 0, -1
    buffer_load_dword v19, v10, s[64:67], s16 offen sc1
    s_mov_b64 exec, -1
    s_add_u32 s11, s10, 196608
    buffer_load_dwordx4 v[192:195], v4, s[72:75], s11 offen
    buffer_load_dwordx4 v[196:199], v5, s[72:75], s11 offen offset:1024
    s_waitcnt vmcnt(8)
    s_add_u32 s11, s10, 212992
    buffer_load_dwordx4 v[200:203], v4, s[72:75], s11 offen
    buffer_load_dwordx4 v[204:207], v5, s[72:75], s11 offen offset:1024
    s_waitcnt vmcnt(8)
    s_add_u32 s11, s10, 229376
    buffer_load_dwordx4 v[208:211], v4, s[72:75], s11 offen
    buffer_load_dwordx4 v[212:215], v5, s[72:75], s11 offen offset:1024
    s_waitcnt vmcnt(8)
    s_add_u32 s11, s10, 245760
    buffer_load_dwordx4 v[216:219], v4, s[72:75], s11 offen
    buffer_load_dwordx4 v[220:223], v5, s[72:75], s11 offen offset:1024
    s_waitcnt vmcnt(8)
    s_mov_b32 s23, 0
    s_cmp_ge_u32 s2, 224
    s_cbranch_scc1 kf_kernel_trs
    s_mov_b32 s18, 2
kf_kernel_trs:
    s_mov_b32 s35, 0
kf_kernel_tr:
    ds_read_b32 v20, v27 offset:80
    s_add_u32 s35, s35, 1
    s_cmp_gt_u32 s35, 65536
    s_cbranch_scc1 kf_kernel_tro
    s_waitcnt lgkmcnt(0)
    v_cmp_gt_u32 vcc, 4, v20
    s_cbranch_vccnz kf_kernel_tr
kf_kernel_tro:
kf_kernel_tr2:
    v_cmp_ne_u32 vcc, v16, v19
    s_cbranch_vccnz kf_kernel_mk
kf_kernel_mko:
    v_add_u32 v10, s14, v12
    s_add_u32 s35, s15, 150528
    v_add_u32 v17, s35, v12
    s_cmp_ge_u32 s2, 224
    s_cbranch_scc1 kf_kernel_lskip
kf_kernel_rg0:
    s_add_u32 m0, s14, 0
    s_add_u32 s12, s33, 0
    s_and_b32 s12, s12, 15
    s_lshl_b32 s12, s12, 13
    s_add_u32 s12, s12, 0x800000
    buffer_load_dwordx4 v8, s[64:67], s12 offen sc1 lds
    s_sub_u32 s12, s12, 1088
    buffer_load_dwordx4 v9, s[64:67], s12 offen offset:1088 sc1 lds
    s_add_u32 m0, s14, 8704
    s_add_u32 s12, s33, 1
    s_and_b32 s12, s12, 15
    s_lshl_b32 s12, s12, 13
    s_add_u32 s12, s12, 0x800000
    buffer_load_dwordx4 v8, s[64:67], s12 offen sc1 lds
    s_sub_u32 s12, s12, 1088
    buffer_load_dwordx4 v9, s[64:67], s12 offen offset:1088 sc1 lds
    s_add_u32 m0, s14, 17408
    s_add_u32 s12, s33, 2
    s_and_b32 s12, s12, 15
    s_lshl_b32 s12, s12, 13
    s_add_u32 s12, s12, 0x800000
    buffer_load_dwordx4 v8, s[64:67], s12 offen sc1 lds
    s_sub_u32 s12, s12, 1088
    buffer_load_dwordx4 v9, s[64:67], s12 offen offset:1088 sc1 lds
    s_add_u32 m0, s14, 26112
    s_add_u32 s12, s33, 3
    s_and_b32 s12, s12, 15
    s_lshl_b32 s12, s12, 13
    s_add_u32 s12, s12, 0x800000
    buffer_load_dwordx4 v8, s[64:67], s12 offen sc1 lds
    s_sub_u32 s12, s12, 1088
    buffer_load_dwordx4 v9, s[64:67], s12 offen offset:1088 sc1 lds
    s_add_u32 m0, s14, 34816
    s_add_u32 s12, s33, 4
    s_and_b32 s12, s12, 15
    s_lshl_b32 s12, s12, 13
    s_add_u32 s12, s12, 0x800000
    buffer_load_dwordx4 v8, s[64:67], s12 offen sc1 lds
    s_sub_u32 s12, s12, 1088
    buffer_load_dwordx4 v9, s[64:67], s12 offen offset:1088 sc1 lds
    s_add_u32 m0, s14, 43520
    s_add_u32 s12, s33, 5
    s_and_b32 s12, s12, 15
    s_lshl_b32 s12, s12, 13
    s_add_u32 s12, s12, 0x800000
    buffer_load_dwordx4 v8, s[64:67], s12 offen sc1 lds
    s_sub_u32 s12, s12, 1088
    buffer_load_dwordx4 v9, s[64:67], s12 offen offset:1088 sc1 lds
    s_add_u32 m0, s14, 52224
    s_add_u32 s12, s33, 6
    s_and_b32 s12, s12, 15
    s_lshl_b32 s12, s12, 13
    s_add_u32 s12, s12, 0x800000
    buffer_load_dwordx4 v8, s[64:67], s12 offen sc1 lds
    s_sub_u32 s12, s12, 1088
    buffer_load_dwordx4 v9, s[64:67], s12 offen offset:1088 sc1 lds
    s_lshl_b32 s21, s34, 14
    s_lshl_b32 s35, s9, 7
    s_add_u32 s21, s21, s35
    s_waitcnt vmcnt(12)
    ds_read_b32 v20, v10 offset:0
    ds_read_b32 v21, v10 offset:1088
    s_waitcnt lgkmcnt(0)
    v_max_u32 v20, v20, v21
    v_cmp_eq_u32 vcc, -1, v20
    s_cbranch_vccnz kf_kernel_g0
kf_kernel_g0o:
    s_barrier
    s_waitcnt vmcnt(10)
    ds_read_b32 v20, v10 offset:8704
    ds_read_b32 v21, v10 offset:9792
    s_waitcnt lgkmcnt(0)
    v_max_u32 v20, v20, v21
    v_cmp_eq_u32 vcc, -1, v20
    s_cbranch_vccnz kf_kernel_g1
kf_kernel_g1o:
    s_waitcnt vmcnt(8)
    ds_read_b32 v20, v10 offset:17408
    ds_read_b32 v21, v10 offset:18496
    s_barrier
    s_add_u32 m0, s14, 0
    s_add_u32 s12, s33, 7
    s_and_b32 s12, s12, 15
    s_lshl_b32 s12, s12, 13
    s_add_u32 s12, s12, 0x800000
    buffer_load_dwordx4 v8, s[64:67], s12 offen sc1 lds
    s_sub_u32 s12, s12, 1088
    buffer_load_dwordx4 v9, s[64:67], s12 offen offset:1088 sc1 lds
    s_waitcnt lgkmcnt(0)
    v_max_u32 v20, v20, v21
    v_cmp_eq_u32 vcc, -1, v20
    s_cbranch_vccnz kf_kernel_g2
kf_kernel_g2o:
    s_waitcnt vmcnt(8)
    ds_read_b32 v20, v10 offset:26112
    ds_read_b32 v21, v10 offset:27200
    s_barrier
    s_add_u32 m0, s14, 8704
    s_add_u32 s12, s33, 8
    s_and_b32 s12, s12, 15
    s_lshl_b32 s12, s12, 13
    s_add_u32 s12, s12, 0x800000
    buffer_load_dwordx4 v8, s[64:67], s12 offen sc1 lds
    s_sub_u32 s12, s12, 1088
    buffer_load_dwordx4 v9, s[64:67], s12 offen offset:1088 sc1 lds
    s_waitcnt lgkmcnt(0)
    v_max_u32 v20, v20, v21
    v_cmp_eq_u32 vcc, -1, v20
    s_cbranch_vccnz kf_kernel_g3
kf_kernel_g3o:
    s_waitcnt vmcnt(8)
    ds_read_b32 v20, v10 offset:34816
    ds_read_b32 v21, v10 offset:35904
    s_barrier
    s_add_u32 m0, s14, 17408
    s_add_u32 s12, s33, 9
    s_and_b32 s12, s12, 15
    s_lshl_b32 s12, s12, 13
    s_add_u32 s12, s12, 0x800000
    buffer_load_dwordx4 v8, s[64:67], s12 offen sc1 lds
    s_sub_u32 s12, s12, 1088
    buffer_load_dwordx4 v9, s[64:67], s12 offen offset:1088 sc1 lds
    s_waitcnt lgkmcnt(0)
    v_max_u32 v20, v20, v21
    v_cmp_eq_u32 vcc, -1, v20
    s_cbranch_vccnz kf_kernel_g4
kf_kernel_g4o:
    s_waitcnt vmcnt(8)
    ds_read_b32 v20, v10 offset:43520
    ds_read_b32 v21, v10 offset:44608
    s_barrier
    s_add_u32 m0, s14, 26112
    s_add_u32 s12, s33, 10
    s_and_b32 s12, s12, 15
    s_lshl_b32 s12, s12, 13
    s_add_u32 s12, s12, 0x800000
    buffer_load_dwordx4 v8, s[64:67], s12 offen sc1 lds
    s_sub_u32 s12, s12, 1088
    buffer_load_dwordx4 v9, s[64:67], s12 offen offset:1088 sc1 lds
    s_waitcnt lgkmcnt(0)
    v_max_u32 v20, v20, v21
    v_cmp_eq_u32 vcc, -1, v20
    s_cbranch_vccnz kf_kernel_g5
kf_kernel_g5o:
    s_waitcnt vmcnt(8)
    ds_read_b32 v20, v10 offset:52224
    ds_read_b32 v21, v10 offset:53312
    s_barrier
    s_add_u32 m0, s14, 34816
    s_add_u32 s12, s33, 11
    s_and_b32 s12, s12, 15
    s_lshl_b32 s12, s12, 13
    s_add_u32 s12, s12, 0x800000
    buffer_load_dwordx4 v8, s[64:67], s12 offen sc1 lds
    s_sub_u32 s12, s12, 1088
    buffer_load_dwordx4 v9, s[64:67], s12 offen offset:1088 sc1 lds
    s_waitcnt lgkmcnt(0)
    v_max_u32 v20, v20, v21
    v_cmp_eq_u32 vcc, -1, v20
    s_cbranch_vccnz kf_kernel_g6
kf_kernel_g6o:
    s_barrier
    s_add_u32 m0, s14, 43520
    s_add_u32 s12, s33, 12
    s_and_b32 s12, s12, 15
    s_lshl_b32 s12, s12, 13
    s_add_u32 s12, s12, 0x800000
    buffer_load_dwordx4 v8, s[64:67], s12 offen sc1 lds
    s_sub_u32 s12, s12, 1088
    buffer_load_dwordx4 v9, s[64:67], s12 offen offset:1088 sc1 lds
    s_add_u32 m0, s15, 0
    s_add_u32 s11, s4, 4
    s_and_b32 s11, s11, 7
    s_mul_i32 s11, s11, 229376
    s_add_u32 s11, s11, 128
    buffer_load_dwordx4 v6, s[68:71], s11 offen lds
    buffer_load_dwordx4 v7, s[68:71], s11 offen offset:1024 lds
    s_waitcnt vmcnt(12)
    s_barrier
    s_add_u32 m0, s14, 52224
    s_add_u32 s12, s33, 13
    s_and_b32 s12, s12, 15
    s_lshl_b32 s12, s12, 13
    s_add_u32 s12, s12, 0x800000
    buffer_load_dwordx4 v8, s[64:67], s12 offen sc1 lds
    s_sub_u32 s12, s12, 1088
    buffer_load_dwordx4 v9, s[64:67], s12 offen offset:1088 sc1 lds
    s_add_u32 m0, s15, 8192
    s_add_u32 s11, s4, 5
    s_and_b32 s11, s11, 7
    s_mul_i32 s11, s11, 229376
    s_add_u32 s11, s11, 128
    buffer_load_dwordx4 v6, s[68:71], s11 offen lds
    buffer_load_dwordx4 v7, s[68:71], s11 offen offset:1024 lds
    s_waitcnt vmcnt(14)
    s_barrier
    s_add_u32 m0, s14, 0
    s_add_u32 s12, s33, 14
    s_and_b32 s12, s12, 15
    s_lshl_b32 s12, s12, 13
    s_add_u32 s12, s12, 0x800000
    buffer_load_dwordx4 v8, s[64:67], s12 offen sc1 lds
    s_sub_u32 s12, s12, 1088
    buffer_load_dwordx4 v9, s[64:67], s12 offen offset:1088 sc1 lds
    s_add_u32 m0, s15, 16384
    s_add_u32 s11, s4, 6
    s_and_b32 s11, s11, 7
    s_mul_i32 s11, s11, 229376
    s_add_u32 s11, s11, 128
    buffer_load_dwordx4 v6, s[68:71], s11 offen lds
    buffer_load_dwordx4 v7, s[68:71], s11 offen offset:1024 lds
    s_waitcnt vmcnt(16)
    s_barrier
    s_add_u32 m0, s14, 8704
    s_add_u32 s12, s33, 15
    s_and_b32 s12, s12, 15
    s_lshl_b32 s12, s12, 13
    s_add_u32 s12, s12, 0x800000
    buffer_load_dwordx4 v8, s[64:67], s12 offen sc1 lds
    s_sub_u32 s12, s12, 1088
    buffer_load_dwordx4 v9, s[64:67], s12 offen offset:1088 sc1 lds
    s_add_u32 m0, s15, 24576
    s_add_u32 s11, s4, 7
    s_and_b32 s11, s11, 7
    s_mul_i32 s11, s11, 229376
    s_add_u32 s11, s11, 128
    buffer_load_dwordx4 v6, s[68:71], s11 offen lds
    buffer_load_dwordx4 v7, s[68:71], s11 offen offset:1024 lds
    s_waitcnt vmcnt(18)
    s_barrier
    s_add_u32 m0, s15, 115712
    s_add_u32 s11, s21, 131072
    buffer_load_dwordx4 v4, s[72:75], s11 offen lds
    buffer_load_dwordx4 v5, s[72:75], s11 offen offset:1024 lds
    s_waitcnt vmcnt(18)
    s_barrier
    s_add_u32 m0, s15, 32768
    s_add_u32 s11, s21, 0
    buffer_load_dwordx4 v4, s[72:75], s11 offen lds
    buffer_load_dwordx4 v5, s[72:75], s11 offen offset:1024 lds
    s_waitcnt vmcnt(18)
    s_barrier
    s_add_u32 m0, s15, 123904
    s_add_u32 s11, s21, 655360
    buffer_load_dwordx4 v4, s[72:75], s11 offen lds
    buffer_load_dwordx4 v5, s[72:75], s11 offen offset:1024 lds
    s_waitcnt vmcnt(16)
    s_barrier
    s_add_u32 m0, s15, 132096
    s_add_u32 s11, s21, 1048576
    buffer_load_dwordx4 v4, s[72:75], s11 offen lds
    buffer_load_dwordx4 v5, s[72:75], s11 offen offset:1024 lds
    s_waitcnt vmcnt(14)
    s_barrier
    s_add_u32 m0, s15, 40960
    s_add_u32 s11, s21, 524288
    buffer_load_dwordx4 v4, s[72:75], s11 offen lds
    buffer_load_dwordx4 v5, s[72:75], s11 offen offset:1024 lds
    s_waitcnt vmcnt(12)
    s_barrier
    s_add_u32 m0, s15, 140288
    s_add_u32 s11, s21, 1572864
    buffer_load_dwordx4 v4, s[72:75], s11 offen lds
    buffer_load_dwordx4 v5, s[72:75], s11 offen offset:1024 lds
    s_mov_b32 s23, 0
    s_waitcnt vmcnt(12)
    s_barrier
    ds_read_b32 v29, v27 offset:88
    s_add_u32 m0, s15, 49152
    s_add_u32 s11, s21, 917504
    buffer_load_dwordx4 v4, s[72:75], s11 offen lds
    buffer_load_dwordx4 v5, s[72:75], s11 offen offset:1024 lds
    s_add_u32 m0, s15, 57344
    s_add_u32 s11, s21, 1441792
    buffer_load_dwordx4 v4, s[72:75], s11 offen lds
    buffer_load_dwordx4 v5, s[72:75], s11 offen offset:1024 lds
    s_add_u32 m0, s15, 150528
    s_nop 0
    buffer_load_dwordx4 v11, s[64:67], s13 offen sc1 lds
    buffer_load_dwordx4 v13, s[64:67], s13 offen offset:1024 sc1 lds
    s_and_b32 s35, s6, 3
    s_lshl_b32 s36, s34, 2
    s_add_u32 s35, s35, s36
    s_cmp_eq_u32 s35, 3
    s_cselect_b32 exec_lo, 0xffff, 0
    s_mov_b32 exec_hi, 0
    s_lshl_b32 s35, s6, 14
    s_lshl_b32 s36, s7, 6
    s_add_u32 s35, s35, s36
    s_add_u32 s35, s35, 0x11c1000
    v_lshlrev_b32 v28, 2, v1
    buffer_store_dword v16, v28, s[64:67], s35 offen sc1
    s_mov_b64 exec, -1
    s_waitcnt lgkmcnt(0)
    v_cmp_ne_u32 vcc, 0, v29
    s_cbranch_vccnz kf_kernel_hre
    s_waitcnt vmcnt(3)
    v_mov_b32 v26, 2
    ds_write_b32 v15, v26 offset:32
    s_waitcnt vmcnt(1)
    s_branch kf_kernel_lw4
kf_kernel_lskip:
    s_barrier
    s_add_u32 m0, s15, 150528
    s_nop 0
    buffer_load_dwordx4 v11, s[64:67], s13 offen sc1 lds
    buffer_load_dwordx4 v13, s[64:67], s13 offen offset:1024 sc1 lds
    s_add_u32 m0, s17, 32768
    s_add_u32 s11, s10, 0
    buffer_load_dwordx4 v4, s[72:75], s11 offen lds
    buffer_load_dwordx4 v5, s[72:75], s11 offen offset:1024 lds
    s_add_u32 m0, s17, 34816
    s_add_u32 s11, s10, 16384
    buffer_load_dwordx4 v4, s[72:75], s11 offen lds
    buffer_load_dwordx4 v5, s[72:75], s11 offen offset:1024 lds
    s_add_u32 m0, s17, 36864
    s_add_u32 s11, s10, 32768
    buffer_load_dwordx4 v4, s[72:75], s11 offen lds
    buffer_load_dwordx4 v5, s[72:75], s11 offen offset:1024 lds
    s_add_u32 m0, s17, 38912
    s_add_u32 s11, s10, 49152
    buffer_load_dwordx4 v4, s[72:75], s11 offen lds
    buffer_load_dwordx4 v5, s[72:75], s11 offen offset:1024 lds
kf_kernel_lw:
    s_add_u32 m0, s17, 115712
    s_add_u32 s11, s10, 131072
    buffer_load_dwordx4 v4, s[72:75], s11 offen lds
    buffer_load_dwordx4 v5, s[72:75], s11 offen offset:1024 lds
    s_waitcnt vmcnt(8)
    s_add_u32 m0, s17, 117760
    s_add_u32 s11, s10, 147456
    buffer_load_dwordx4 v4, s[72:75], s11 offen lds
    buffer_load_dwordx4 v5, s[72:75], s11 offen offset:1024 lds
    s_waitcnt vmcnt(8)
    s_add_u32 m0, s17, 119808
    s_add_u32 s11, s10, 163840
    buffer_load_dwordx4 v4, s[72:75], s11 offen lds
    buffer_load_dwordx4 v5, s[72:75], s11 offen offset:1024 lds
    s_waitcnt vmcnt(8)
    s_add_u32 m0, s17, 121856
    s_add_u32 s11, s10, 180224
    buffer_load_dwordx4 v4, s[72:75], s11 offen lds
    buffer_load_dwordx4 v5, s[72:75], s11 offen offset:1024 lds
    s_waitcnt vmcnt(8)
kf_kernel_lw3:
    s_waitcnt vmcnt(0)
    v_mov_b32 v26, 2
    ds_write_b32 v15, v26 offset:32
kf_kernel_lw4:
    ds_read_b32 v20, v17 offset:0
    ds_read_b32 v21, v17 offset:1024
    s_waitcnt lgkmcnt(0)
    v_max_u32 v20, v20, v21
    v_cmp_eq_u32 vcc, -1, v20
    s_cbranch_vccnz kf_kernel_gr
kf_kernel_gro:
    s_mov_b32 s35, 0
kf_kernel_ls1:
    ds_read_b128 v[20:23], v27 offset:32
    s_add_u32 s35, s35, 1
    s_cmp_gt_u32 s35, 65536
    s_cbranch_scc1 kf_kernel_ls1o
    s_waitcnt lgkmcnt(0)
    v_min_u32 v20, v20, v21
    v_min3_u32 v20, v20, v22, v23
    v_cmp_gt_u32 vcc, 3, v20
    s_cbranch_vccnz kf_kernel_ls1
kf_kernel_ls1o:
    s_add_u32 s35, s17, 65536
    v_add_u32 v24, s35, v12
    s_waitcnt lgkmcnt(5)
    ds_write_b128 v24, v[96:99] offset:0
    ds_write_b128 v24, v[100:103] offset:1024
    ds_write_b128 v24, v[104:107] offset:2048
    ds_write_b128 v24, v[108:111] offset:3072
    ds_write_b128 v24, v[112:115] offset:4096
    ds_write_b128 v24, v[116:119] offset:5120
    ds_write_b128 v24, v[120:123] offset:6144
    ds_write_b128 v24, v[124:127] offset:7168
    v_mov_b32 v26, 3
    ds_write_b32 v15, v26 offset:32
    s_add_u32 s35, s17, 0
    v_add_u32 v24, s35, v12
    s_waitcnt lgkmcnt(5)
    ds_write_b128 v24, v[128:131] offset:0
    ds_write_b128 v24, v[132:135] offset:1024
    ds_write_b128 v24, v[136:139] offset:2048
    ds_write_b128 v24, v[140:143] offset:3072
    ds_write_b128 v24, v[144:147] offset:4096
    ds_write_b128 v24, v[148:151] offset:5120
    ds_write_b128 v24, v[152:155] offset:6144
    ds_write_b128 v24, v[156:159] offset:7168
    v_mov_b32 v26, 4
    ds_write_b32 v15, v26 offset:32
    s_lshl_b32 s37, s8, 13
    s_add_u32 s37, s37, 0x11c0800
    s_cmp_eq_u32 s34, 0
    s_cselect_b32 exec_lo, 1, 0
    s_mov_b32 exec_hi, 0
    buffer_load_dword v28, v25, s[64:67], s37 offen sc1
    s_mov_b64 exec, -1
    s_add_u32 s35, s17, 32768
    v_add_u32 v24, s35, v12
    s_waitcnt lgkmcnt(5)
    ds_write_b128 v24, v[160:163] offset:0
    ds_write_b128 v24, v[164:167] offset:1024
    ds_write_b128 v24, v[168:171] offset:2048
    ds_write_b128 v24, v[172:175] offset:3072
    ds_write_b128 v24, v[176:179] offset:4096
    ds_write_b128 v24, v[180:183] offset:5120
    ds_write_b128 v24, v[184:187] offset:6144
    ds_write_b128 v24, v[188:191] offset:7168
    v_mov_b32 v26, 5
    ds_write_b32 v15, v26 offset:32
    s_add_u32 s35, s17, 115712
    v_add_u32 v24, s35, v12
    s_waitcnt lgkmcnt(5)
    ds_write_b128 v24, v[192:195] offset:0
    ds_write_b128 v24, v[196:199] offset:1024
    ds_write_b128 v24, v[200:203] offset:2048
    ds_write_b128 v24, v[204:207] offset:3072
    ds_write_b128 v24, v[208:211] offset:4096
    ds_write_b128 v24, v[212:215] offset:5120
    ds_write_b128 v24, v[216:219] offset:6144
    ds_write_b128 v24, v[220:223] offset:7168
    v_mov_b32 v26, 6
    ds_write_b32 v15, v26 offset:32
    s_cmp_lg_u32 s34, 0
    s_cbranch_scc1 kf_kernel_lr
    s_mov_b64 exec, 1
    s_mov_b32 s35, 0
    s_branch kf_kernel_lspin2
kf_kernel_lspin:
    s_sleep 16
kf_kernel_lspin1:
    buffer_load_dword v28, v25, s[64:67], s37 offen sc1
    s_add_u32 s35, s35, 1
    s_cmp_gt_u32 s35, 65536
    s_cbranch_scc1 kf_kernel_lgot
kf_kernel_lspin2:
    s_waitcnt vmcnt(0)
    v_cmp_ne_u32 vcc, v16, v28
    s_cbranch_vccnz kf_kernel_lspin
kf_kernel_lgot:
    s_mov_b64 exec, -1
    s_mov_b32 m0, 159232
    s_lshl_b32 s36, s8, 8
    s_add_u32 s36, s36, 0x1110000
    v_lshlrev_b32 v2, 2, v1
    buffer_load_dword v2, s[64:67], s36 offen sc1 lds
kf_kernel_lr:
    s_mov_b32 s35, 0
kf_kernel_ls3:
    ds_read_b32 v20, v15 offset:16
    s_add_u32 s35, s35, 1
    s_cmp_gt_u32 s35, 65536
    s_cbranch_scc1 kf_kernel_ls3o
    s_waitcnt lgkmcnt(0)
    v_cmp_gt_u32 vcc, 5, v20
    s_cbranch_vccnz kf_kernel_ls3
kf_kernel_ls3o:
    s_add_u32 s35, s17, 65536
    v_add_u32 v24, s35, v12
    s_waitcnt lgkmcnt(5)
    ds_write_b128 v24, v[224:227] offset:0
    ds_write_b128 v24, v[228:231] offset:1024
    ds_write_b128 v24, v[232:235] offset:2048
    ds_write_b128 v24, v[236:239] offset:3072
    ds_write_b128 v24, v[240:243] offset:4096
    ds_write_b128 v24, v[244:247] offset:5120
    ds_write_b128 v24, v[248:251] offset:6144
    ds_write_b128 v24, v[252:255] offset:7168
    v_mov_b32 v26, 7
    ds_write_b32 v15, v26 offset:32
    s_waitcnt vmcnt(0)
    v_mov_b32 v26, 8
    ds_write_b32 v15, v26 offset:32
    s_waitcnt lgkmcnt(0)
    s_barrier
    s_endpgm
kf_kernel_again:
    s_cmp_ge_u32 s76, 65536
    s_cbranch_scc1 kf_kernel_okp
    s_mov_b64 exec, s[44:45]
    buffer_load_dwordx4 v[112:115], v11, s[64:67], s40 offen sc1
    s_mov_b64 exec, s[46:47]
    buffer_load_dwordx4 v[116:119], v11, s[64:67], s41 offen sc1
    s_mov_b64 exec, s[48:49]
    buffer_load_dwordx4 v[120:123], v11, s[64:67], s42 offen sc1
    s_mov_b64 exec, s[50:51]
    buffer_load_dwordx4 v[124:127], v11, s[64:67], s43 offen sc1
    s_mov_b64 exec, s[52:53]
    buffer_load_dwordx4 v[128:131], v12, s[64:67], s39 offen offset:0 sc1
    s_mov_b64 exec, s[54:55]
    buffer_load_dwordx4 v[132:135], v12, s[64:67], s39 offen offset:1024 sc1
    s_mov_b64 exec, s[56:57]
    buffer_load_dwordx4 v[136:139], v12, s[64:67], s39 offen offset:2048 sc1
    s_mov_b64 exec, s[58:59]
    buffer_load_dwordx4 v[140:143], v12, s[64:67], s39 offen offset:3072 sc1
    s_mov_b64 exec, -1
    s_branch kf_kernel_chk
kf_kernel_mk:
    s_sleep 4
    s_cmp_lt_u32 s2, 224
    s_cbranch_scc1 kf_kernel_mkb
    s_sleep 32
kf_kernel_mkb:
    s_mov_b64 exec, vcc
    buffer_load_dword v19, v10, s[64:67], s16 offen sc1
    s_add_u32 s77, s77, 256
    s_cmp_gt_u32 s77, 16777216
    s_waitcnt vmcnt(0)
    s_mov_b64 exec, -1
    s_cbranch_scc1 kf_kernel_mko
    v_cmp_ne_u32 vcc, v16, v19
    s_cbranch_vccnz kf_kernel_mk
    s_branch kf_kernel_mko
kf_kernel_g0:
    s_add_u32 m0, s14, 0
    s_add_u32 s12, s33, 0
    s_and_b32 s12, s12, 15
    s_lshl_b32 s12, s12, 13
    s_add_u32 s12, s12, 0x800000
    buffer_load_dwordx4 v8, s[64:67], s12 offen sc1 lds
    s_sub_u32 s12, s12, 1088
    buffer_load_dwordx4 v9, s[64:67], s12 offen offset:1088 sc1 lds
    s_add_u32 m0, s14, 8704
    s_add_u32 s12, s33, 1
    s_and_b32 s12, s12, 15
    s_lshl_b32 s12, s12, 13
    s_add_u32 s12, s12, 0x800000
    buffer_load_dwordx4 v8, s[64:67], s12 offen sc1 lds
    s_sub_u32 s12, s12, 1088
    buffer_load_dwordx4 v9, s[64:67], s12 offen offset:1088 sc1 lds
    s_add_u32 m0, s14, 17408
    s_add_u32 s12, s33, 2
    s_and_b32 s12, s12, 15
    s_lshl_b32 s12, s12, 13
    s_add_u32 s12, s12, 0x800000
    buffer_load_dwordx4 v8, s[64:67], s12 offen sc1 lds
    s_sub_u32 s12, s12, 1088
    buffer_load_dwordx4 v9, s[64:67], s12 offen offset:1088 sc1 lds
    s_add_u32 m0, s14, 26112
    s_add_u32 s12, s33, 3
    s_and_b32 s12, s12, 15
    s_lshl_b32 s12, s12, 13
    s_add_u32 s12, s12, 0x800000
    buffer_load_dwordx4 v8, s[64:67], s12 offen sc1 lds
    s_sub_u32 s12, s12, 1088
    buffer_load_dwordx4 v9, s[64:67], s12 offen offset:1088 sc1 lds
    s_add_u32 m0, s14, 34816
    s_add_u32 s12, s33, 4
    s_and_b32 s12, s12, 15
    s_lshl_b32 s12, s12, 13
    s_add_u32 s12, s12, 0x800000
    buffer_load_dwordx4 v8, s[64:67], s12 offen sc1 lds
    s_sub_u32 s12, s12, 1088
    buffer_load_dwordx4 v9, s[64:67], s12 offen offset:1088 sc1 lds
    s_add_u32 m0, s14, 43520
    s_add_u32 s12, s33, 5
    s_and_b32 s12, s12, 15
    s_lshl_b32 s12, s12, 13
    s_add_u32 s12, s12, 0x800000
    buffer_load_dwordx4 v8, s[64:67], s12 offen sc1 lds
    s_sub_u32 s12, s12, 1088
    buffer_load_dwordx4 v9, s[64:67], s12 offen offset:1088 sc1 lds
    s_add_u32 m0, s14, 52224
    s_add_u32 s12, s33, 6
    s_and_b32 s12, s12, 15
    s_lshl_b32 s12, s12, 13
    s_add_u32 s12, s12, 0x800000
    buffer_load_dwordx4 v8, s[64:67], s12 offen sc1 lds
    s_sub_u32 s12, s12, 1088
    buffer_load_dwordx4 v9, s[64:67], s12 offen offset:1088 sc1 lds
    s_add_u32 s77, s77, 256
    s_cmp_gt_u32 s77, 16777216
    s_waitcnt vmcnt(0)
    s_cbranch_scc1 kf_kernel_g0o
    ds_read_b32 v20, v10 offset:0
    ds_read_b32 v21, v10 offset:1088
    s_waitcnt lgkmcnt(0)
    v_max_u32 v20, v20, v21
    v_cmp_eq_u32 vcc, -1, v20
    s_cbranch_vccnz kf_kernel_g0
    s_branch kf_kernel_g0o
kf_kernel_g1:
    s_add_u32 m0, s14, 8704
    s_add_u32 s12, s33, 1
    s_and_b32 s12, s12, 15
    s_lshl_b32 s12, s12, 13
    s_add_u32 s12, s12, 0x800000
    buffer_load_dwordx4 v8, s[64:67], s12 offen sc1 lds
    s_sub_u32 s12, s12, 1088
    buffer_load_dwordx4 v9, s[64:67], s12 offen offset:1088 sc1 lds
    s_add_u32 m0, s14, 17408
    s_add_u32 s12, s33, 2
    s_and_b32 s12, s12, 15
    s_lshl_b32 s12, s12, 13
    s_add_u32 s12, s12, 0x800000
    buffer_load_dwordx4 v8, s[64:67], s12 offen sc1 lds
    s_sub_u32 s12, s12, 1088
    buffer_load_dwordx4 v9, s[64:67], s12 offen offset:1088 sc1 lds
    s_add_u32 m0, s14, 26112
    s_add_u32 s12, s33, 3
    s_and_b32 s12, s12, 15
    s_lshl_b32 s12, s12, 13
    s_add_u32 s12, s12, 0x800000
    buffer_load_dwordx4 v8, s[64:67], s12 offen sc1 lds
    s_sub_u32 s12, s12, 1088
    buffer_load_dwordx4 v9, s[64:67], s12 offen offset:1088 sc1 lds
    s_add_u32 m0, s14, 34816
    s_add_u32 s12, s33, 4
    s_and_b32 s12, s12, 15
    s_lshl_b32 s12, s12, 13
    s_add_u32 s12, s12, 0x800000
    buffer_load_dwordx4 v8, s[64:67], s12 offen sc1 lds
    s_sub_u32 s12, s12, 1088
    buffer_load_dwordx4 v9, s[64:67], s12 offen offset:1088 sc1 lds
    s_add_u32 m0, s14, 43520
    s_add_u32 s12, s33, 5
    s_and_b32 s12, s12, 15
    s_lshl_b32 s12, s12, 13
    s_add_u32 s12, s12, 0x800000
    buffer_load_dwordx4 v8, s[64:67], s12 offen sc1 lds
    s_sub_u32 s12, s12, 1088
    buffer_load_dwordx4 v9, s[64:67], s12 offen offset:1088 sc1 lds
    s_add_u32 m0, s14, 52224
    s_add_u32 s12, s33, 6
    s_and_b32 s12, s12, 15
    s_lshl_b32 s12, s12, 13
    s_add_u32 s12, s12, 0x800000
    buffer_load_dwordx4 v8, s[64:67], s12 offen sc1 lds
    s_sub_u32 s12, s12, 1088
    buffer_load_dwordx4 v9, s[64:67], s12 offen offset:1088 sc1 lds
    s_add_u32 s77, s77, 256
    s_cmp_gt_u32 s77, 16777216
    s_waitcnt vmcnt(0)
    s_cbranch_scc1 kf_kernel_g1o
    ds_read_b32 v20, v10 offset:8704
    ds_read_b32 v21, v10 offset:9792
    s_waitcnt lgkmcnt(0)
    v_max_u32 v20, v20, v21
    v_cmp_eq_u32 vcc, -1, v20
    s_cbranch_vccnz kf_kernel_g1
    s_branch kf_kernel_g1o
kf_kernel_g2:
    s_add_u32 m0, s14, 17408
    s_add_u32 s12, s33, 2
    s_and_b32 s12, s12, 15
    s_lshl_b32 s12, s12, 13
    s_add_u32 s12, s12, 0x800000
    buffer_load_dwordx4 v8, s[64:67], s12 offen sc1 lds
    s_sub_u32 s12, s12, 1088
    buffer_load_dwordx4 v9, s[64:67], s12 offen offset:1088 sc1 lds
    s_add_u32 m0, s14, 26112
    s_add_u32 s12, s33, 3
    s_and_b32 s12, s12, 15
    s_lshl_b32 s12, s12, 13
    s_add_u32 s12, s12, 0x800000
    buffer_load_dwordx4 v8, s[64:67], s12 offen sc1 lds
    s_sub_u32 s12, s12, 1088
    buffer_load_dwordx4 v9, s[64:67], s12 offen offset:1088 sc1 lds
    s_add_u32 m0, s14, 34816
    s_add_u32 s12, s33, 4
    s_and_b32 s12, s12, 15
    s_lshl_b32 s12, s12, 13
    s_add_u32 s12, s12, 0x800000
    buffer_load_dwordx4 v8, s[64:67], s12 offen sc1 lds
    s_sub_u32 s12, s12, 1088
    buffer_load_dwordx4 v9, s[64:67], s12 offen offset:1088 sc1 lds
    s_add_u32 m0, s14, 43520
    s_add_u32 s12, s33, 5
    s_and_b32 s12, s12, 15
    s_lshl_b32 s12, s12, 13
    s_add_u32 s12, s12, 0x800000
    buffer_load_dwordx4 v8, s[64:67], s12 offen sc1 lds
    s_sub_u32 s12, s12, 1088
    buffer_load_dwordx4 v9, s[64:67], s12 offen offset:1088 sc1 lds
    s_add_u32 m0, s14, 52224
    s_add_u32 s12, s33, 6
    s_and_b32 s12, s12, 15
    s_lshl_b32 s12, s12, 13
    s_add_u32 s12, s12, 0x800000
    buffer_load_dwordx4 v8, s[64:67], s12 offen sc1 lds
    s_sub_u32 s12, s12, 1088
    buffer_load_dwordx4 v9, s[64:67], s12 offen offset:1088 sc1 lds
    s_add_u32 m0, s14, 0
    s_add_u32 s12, s33, 7
    s_and_b32 s12, s12, 15
    s_lshl_b32 s12, s12, 13
    s_add_u32 s12, s12, 0x800000
    buffer_load_dwordx4 v8, s[64:67], s12 offen sc1 lds
    s_sub_u32 s12, s12, 1088
    buffer_load_dwordx4 v9, s[64:67], s12 offen offset:1088 sc1 lds
    s_add_u32 s77, s77, 256
    s_cmp_gt_u32 s77, 16777216
    s_waitcnt vmcnt(0)
    s_cbranch_scc1 kf_kernel_g2o
    ds_read_b32 v20, v10 offset:17408
    ds_read_b32 v21, v10 offset:18496
    s_waitcnt lgkmcnt(0)
    v_max_u32 v20, v20, v21
    v_cmp_eq_u32 vcc, -1, v20
    s_cbranch_vccnz kf_kernel_g2
    s_branch kf_kernel_g2o
kf_kernel_g3:
    s_add_u32 m0, s14, 26112
    s_add_u32 s12, s33, 3
    s_and_b32 s12, s12, 15
    s_lshl_b32 s12, s12, 13
    s_add_u32 s12, s12, 0x800000
    buffer_load_dwordx4 v8, s[64:67], s12 offen sc1 lds
    s_sub_u32 s12, s12, 1088
    buffer_load_dwordx4 v9, s[64:67], s12 offen offset:1088 sc1 lds
    s_add_u32 m0, s14, 34816
    s_add_u32 s12, s33, 4
    s_and_b32 s12, s12, 15
    s_lshl_b32 s12, s12, 13
    s_add_u32 s12, s12, 0x800000
    buffer_load_dwordx4 v8, s[64:67], s12 offen sc1 lds
    s_sub_u32 s12, s12, 1088
    buffer_load_dwordx4 v9, s[64:67], s12 offen offset:1088 sc1 lds
    s_add_u32 m0, s14, 43520
    s_add_u32 s12, s33, 5
    s_and_b32 s12, s12, 15
    s_lshl_b32 s12, s12, 13
    s_add_u32 s12, s12, 0x800000
    buffer_load_dwordx4 v8, s[64:67], s12 offen sc1 lds
    s_sub_u32 s12, s12, 1088
    buffer_load_dwordx4 v9, s[64:67], s12 offen offset:1088 sc1 lds
    s_add_u32 m0, s14, 52224
    s_add_u32 s12, s33, 6
    s_and_b32 s12, s12, 15
    s_lshl_b32 s12, s12, 13
    s_add_u32 s12, s12, 0x800000
    buffer_load_dwordx4 v8, s[64:67], s12 offen sc1 lds
    s_sub_u32 s12, s12, 1088
    buffer_load_dwordx4 v9, s[64:67], s12 offen offset:1088 sc1 lds
    s_add_u32 m0, s14, 0
    s_add_u32 s12, s33, 7
    s_and_b32 s12, s12, 15
    s_lshl_b32 s12, s12, 13
    s_add_u32 s12, s12, 0x800000
    buffer_load_dwordx4 v8, s[64:67], s12 offen sc1 lds
    s_sub_u32 s12, s12, 1088
    buffer_load_dwordx4 v9, s[64:67], s12 offen offset:1088 sc1 lds
    s_add_u32 m0, s14, 8704
    s_add_u32 s12, s33, 8
    s_and_b32 s12, s12, 15
    s_lshl_b32 s12, s12, 13
    s_add_u32 s12, s12, 0x800000
    buffer_load_dwordx4 v8, s[64:67], s12 offen sc1 lds
    s_sub_u32 s12, s12, 1088
    buffer_load_dwordx4 v9, s[64:67], s12 offen offset:1088 sc1 lds
    s_add_u32 s77, s77, 256
    s_cmp_gt_u32 s77, 16777216
    s_waitcnt vmcnt(0)
    s_cbranch_scc1 kf_kernel_g3o
    ds_read_b32 v20, v10 offset:26112
    ds_read_b32 v21, v10 offset:27200
    s_waitcnt lgkmcnt(0)
    v_max_u32 v20, v20, v21
    v_cmp_eq_u32 vcc, -1, v20
    s_cbranch_vccnz kf_kernel_g3
    s_branch kf_kernel_g3o
kf_kernel_g4:
    s_add_u32 m0, s14, 34816
    s_add_u32 s12, s33, 4
    s_and_b32 s12, s12, 15
    s_lshl_b32 s12, s12, 13
    s_add_u32 s12, s12, 0x800000
    buffer_load_dwordx4 v8, s[64:67], s12 offen sc1 lds
    s_sub_u32 s12, s12, 1088
    buffer_load_dwordx4 v9, s[64:67], s12 offen offset:1088 sc1 lds
    s_add_u32 m0, s14, 43520
    s_add_u32 s12, s33, 5
    s_and_b32 s12, s12, 15
    s_lshl_b32 s12, s12, 13
    s_add_u32 s12, s12, 0x800000
    buffer_load_dwordx4 v8, s[64:67], s12 offen sc1 lds
    s_sub_u32 s12, s12, 1088
    buffer_load_dwordx4 v9, s[64:67], s12 offen offset:1088 sc1 lds
    s_add_u32 m0, s14, 52224
    s_add_u32 s12, s33, 6
    s_and_b32 s12, s12, 15
    s_lshl_b32 s12, s12, 13
    s_add_u32 s12, s12, 0x800000
    buffer_load_dwordx4 v8, s[64:67], s12 offen sc1 lds
    s_sub_u32 s12, s12, 1088
    buffer_load_dwordx4 v9, s[64:67], s12 offen offset:1088 sc1 lds
    s_add_u32 m0, s14, 0
    s_add_u32 s12, s33, 7
    s_and_b32 s12, s12, 15
    s_lshl_b32 s12, s12, 13
    s_add_u32 s12, s12, 0x800000
    buffer_load_dwordx4 v8, s[64:67], s12 offen sc1 lds
    s_sub_u32 s12, s12, 1088
    buffer_load_dwordx4 v9, s[64:67], s12 offen offset:1088 sc1 lds
    s_add_u32 m0, s14, 8704
    s_add_u32 s12, s33, 8
    s_and_b32 s12, s12, 15
    s_lshl_b32 s12, s12, 13
    s_add_u32 s12, s12, 0x800000
    buffer_load_dwordx4 v8, s[64:67], s12 offen sc1 lds
    s_sub_u32 s12, s12, 1088
    buffer_load_dwordx4 v9, s[64:67], s12 offen offset:1088 sc1 lds
    s_add_u32 m0, s14, 17408
    s_add_u32 s12, s33, 9
    s_and_b32 s12, s12, 15
    s_lshl_b32 s12, s12, 13
    s_add_u32 s12, s12, 0x800000
    buffer_load_dwordx4 v8, s[64:67], s12 offen sc1 lds
    s_sub_u32 s12, s12, 1088
    buffer_load_dwordx4 v9, s[64:67], s12 offen offset:1088 sc1 lds
    s_add_u32 s77, s77, 256
    s_cmp_gt_u32 s77, 16777216
    s_waitcnt vmcnt(0)
    s_cbranch_scc1 kf_kernel_g4o
    ds_read_b32 v20, v10 offset:34816
    ds_read_b32 v21, v10 offset:35904
    s_waitcnt lgkmcnt(0)
    v_max_u32 v20, v20, v21
    v_cmp_eq_u32 vcc, -1, v20
    s_cbranch_vccnz kf_kernel_g4
    s_branch kf_kernel_g4o
kf_kernel_g5:
    s_add_u32 m0, s14, 43520
    s_add_u32 s12, s33, 5
    s_and_b32 s12, s12, 15
    s_lshl_b32 s12, s12, 13
    s_add_u32 s12, s12, 0x800000
    buffer_load_dwordx4 v8, s[64:67], s12 offen sc1 lds
    s_sub_u32 s12, s12, 1088
    buffer_load_dwordx4 v9, s[64:67], s12 offen offset:1088 sc1 lds
    s_add_u32 m0, s14, 52224
    s_add_u32 s12, s33, 6
    s_and_b32 s12, s12, 15
    s_lshl_b32 s12, s12, 13
    s_add_u32 s12, s12, 0x800000
    buffer_load_dwordx4 v8, s[64:67], s12 offen sc1 lds
    s_sub_u32 s12, s12, 1088
    buffer_load_dwordx4 v9, s[64:67], s12 offen offset:1088 sc1 lds
    s_add_u32 m0, s14, 0
    s_add_u32 s12, s33, 7
    s_and_b32 s12, s12, 15
    s_lshl_b32 s12, s12, 13
    s_add_u32 s12, s12, 0x800000
    buffer_load_dwordx4 v8, s[64:67], s12 offen sc1 lds
    s_sub_u32 s12, s12, 1088
    buffer_load_dwordx4 v9, s[64:67], s12 offen offset:1088 sc1 lds
    s_add_u32 m0, s14, 8704
    s_add_u32 s12, s33, 8
    s_and_b32 s12, s12, 15
    s_lshl_b32 s12, s12, 13
    s_add_u32 s12, s12, 0x800000
    buffer_load_dwordx4 v8, s[64:67], s12 offen sc1 lds
    s_sub_u32 s12, s12, 1088
    buffer_load_dwordx4 v9, s[64:67], s12 offen offset:1088 sc1 lds
    s_add_u32 m0, s14, 17408
    s_add_u32 s12, s33, 9
    s_and_b32 s12, s12, 15
    s_lshl_b32 s12, s12, 13
    s_add_u32 s12, s12, 0x800000
    buffer_load_dwordx4 v8, s[64:67], s12 offen sc1 lds
    s_sub_u32 s12, s12, 1088
    buffer_load_dwordx4 v9, s[64:67], s12 offen offset:1088 sc1 lds
    s_add_u32 m0, s14, 26112
    s_add_u32 s12, s33, 10
    s_and_b32 s12, s12, 15
    s_lshl_b32 s12, s12, 13
    s_add_u32 s12, s12, 0x800000
    buffer_load_dwordx4 v8, s[64:67], s12 offen sc1 lds
    s_sub_u32 s12, s12, 1088
    buffer_load_dwordx4 v9, s[64:67], s12 offen offset:1088 sc1 lds
    s_add_u32 s77, s77, 256
    s_cmp_gt_u32 s77, 16777216
    s_waitcnt vmcnt(0)
    s_cbranch_scc1 kf_kernel_g5o
    ds_read_b32 v20, v10 offset:43520
    ds_read_b32 v21, v10 offset:44608
    s_waitcnt lgkmcnt(0)
    v_max_u32 v20, v20, v21
    v_cmp_eq_u32 vcc, -1, v20
    s_cbranch_vccnz kf_kernel_g5
    s_branch kf_kernel_g5o
kf_kernel_g6:
    s_add_u32 m0, s14, 52224
    s_add_u32 s12, s33, 6
    s_and_b32 s12, s12, 15
    s_lshl_b32 s12, s12, 13
    s_add_u32 s12, s12, 0x800000
    buffer_load_dwordx4 v8, s[64:67], s12 offen sc1 lds
    s_sub_u32 s12, s12, 1088
    buffer_load_dwordx4 v9, s[64:67], s12 offen offset:1088 sc1 lds
    s_add_u32 m0, s14, 0
    s_add_u32 s12, s33, 7
    s_and_b32 s12, s12, 15
    s_lshl_b32 s12, s12, 13
    s_add_u32 s12, s12, 0x800000
    buffer_load_dwordx4 v8, s[64:67], s12 offen sc1 lds
    s_sub_u32 s12, s12, 1088
    buffer_load_dwordx4 v9, s[64:67], s12 offen offset:1088 sc1 lds
    s_add_u32 m0, s14, 8704
    s_add_u32 s12, s33, 8
    s_and_b32 s12, s12, 15
    s_lshl_b32 s12, s12, 13
    s_add_u32 s12, s12, 0x800000
    buffer_load_dwordx4 v8, s[64:67], s12 offen sc1 lds
    s_sub_u32 s12, s12, 1088
    buffer_load_dwordx4 v9, s[64:67], s12 offen offset:1088 sc1 lds
    s_add_u32 m0, s14, 17408
    s_add_u32 s12, s33, 9
    s_and_b32 s12, s12, 15
    s_lshl_b32 s12, s12, 13
    s_add_u32 s12, s12, 0x800000
    buffer_load_dwordx4 v8, s[64:67], s12 offen sc1 lds
    s_sub_u32 s12, s12, 1088
    buffer_load_dwordx4 v9, s[64:67], s12 offen offset:1088 sc1 lds
    s_add_u32 m0, s14, 26112
    s_add_u32 s12, s33, 10
    s_and_b32 s12, s12, 15
    s_lshl_b32 s12, s12, 13
    s_add_u32 s12, s12, 0x800000
    buffer_load_dwordx4 v8, s[64:67], s12 offen sc1 lds
    s_sub_u32 s12, s12, 1088
    buffer_load_dwordx4 v9, s[64:67], s12 offen offset:1088 sc1 lds
    s_add_u32 m0, s14, 34816
    s_add_u32 s12, s33, 11
    s_and_b32 s12, s12, 15
    s_lshl_b32 s12, s12, 13
    s_add_u32 s12, s12, 0x800000
    buffer_load_dwordx4 v8, s[64:67], s12 offen sc1 lds
    s_sub_u32 s12, s12, 1088
    buffer_load_dwordx4 v9, s[64:67], s12 offen offset:1088 sc1 lds
    s_add_u32 s77, s77, 256
    s_cmp_gt_u32 s77, 16777216
    s_waitcnt vmcnt(0)
    s_cbranch_scc1 kf_kernel_g6o
    ds_read_b32 v20, v10 offset:52224
    ds_read_b32 v21, v10 offset:53312
    s_waitcnt lgkmcnt(0)
    v_max_u32 v20, v20, v21
    v_cmp_eq_u32 vcc, -1, v20
    s_cbranch_vccnz kf_kernel_g6
    s_branch kf_kernel_g6o
kf_kernel_hre:
    s_waitcnt vmcnt(0)
    s_barrier
    ds_write_b32 v27, v25 offset:88
    s_add_u32 m0, s15, 0
    s_add_u32 s11, s4, 0
    s_and_b32 s11, s11, 7
    s_mul_i32 s11, s11, 229376
    buffer_load_dwordx4 v6, s[68:71], s11 offen lds
    buffer_load_dwordx4 v7, s[68:71], s11 offen offset:1024 lds
    s_add_u32 m0, s15, 8192
    s_add_u32 s11, s4, 1
    s_and_b32 s11, s11, 7
    s_mul_i32 s11, s11, 229376
    buffer_load_dwordx4 v6, s[68:71], s11 offen lds
    buffer_load_dwordx4 v7, s[68:71], s11 offen offset:1024 lds
    s_add_u32 m0, s15, 16384
    s_add_u32 s11, s4, 2
    s_and_b32 s11, s11, 7
    s_mul_i32 s11, s11, 229376
    buffer_load_dwordx4 v6, s[68:71], s11 offen lds
    buffer_load_dwordx4 v7, s[68:71], s11 offen offset:1024 lds
    s_add_u32 m0, s15, 24576
    s_add_u32 s11, s4, 3
    s_and_b32 s11, s11, 7
    s_mul_i32 s11, s11, 229376
    buffer_load_dwordx4 v6, s[68:71], s11 offen lds
    buffer_load_dwordx4 v7, s[68:71], s11 offen offset:1024 lds
    s_add_u32 m0, s15, 32768
    s_add_u32 s11, s4, 4
    s_and_b32 s11, s11, 7
    s_mul_i32 s11, s11, 229376
    buffer_load_dwordx4 v6, s[68:71], s11 offen lds
    buffer_load_dwordx4 v7, s[68:71], s11 offen offset:1024 lds
    s_add_u32 m0, s15, 40960
    s_add_u32 s11, s4, 5
    s_and_b32 s11, s11, 7
    s_mul_i32 s11, s11, 229376
    buffer_load_dwordx4 v6, s[68:71], s11 offen lds
    buffer_load_dwordx4 v7, s[68:71], s11 offen offset:1024 lds
    s_add_u32 m0, s15, 49152
    s_add_u32 s11, s4, 6
    s_and_b32 s11, s11, 7
    s_mul_i32 s11, s11, 229376
    buffer_load_dwordx4 v6, s[68:71], s11 offen lds
    buffer_load_dwordx4 v7, s[68:71], s11 offen offset:1024 lds
    s_add_u32 m0, s15, 57344
    s_add_u32 s11, s4, 7
    s_and_b32 s11, s11, 7
    s_mul_i32 s11, s11, 229376
    buffer_load_dwordx4 v6, s[68:71], s11 offen lds
    buffer_load_dwordx4 v7, s[68:71], s11 offen offset:1024 lds
    s_add_u32 m0, s15, 65536
    s_add_u32 s11, s4, 0
    s_and_b32 s11, s11, 7
    s_mul_i32 s11, s11, 229376
    s_add_u32 s11, s11, 128
    buffer_load_dwordx4 v6, s[68:71], s11 offen lds
    buffer_load_dwordx4 v7, s[68:71], s11 offen offset:1024 lds
    s_add_u32 m0, s15, 73728
    s_add_u32 s11, s4, 1
    s_and_b32 s11, s11, 7
    s_mul_i32 s11, s11, 229376
    s_add_u32 s11, s11, 128
    buffer_load_dwordx4 v6, s[68:71], s11 offen lds
    buffer_load_dwordx4 v7, s[68:71], s11 offen offset:1024 lds
    s_add_u32 m0, s15, 81920
    s_add_u32 s11, s4, 2
    s_and_b32 s11, s11, 7
    s_mul_i32 s11, s11, 229376
    s_add_u32 s11, s11, 128
    buffer_load_dwordx4 v6, s[68:71], s11 offen lds
    buffer_load_dwordx4 v7, s[68:71], s11 offen offset:1024 lds
    s_add_u32 m0, s15, 90112
    s_add_u32 s11, s4, 3
    s_and_b32 s11, s11, 7
    s_mul_i32 s11, s11, 229376
    s_add_u32 s11, s11, 128
    buffer_load_dwordx4 v6, s[68:71], s11 offen lds
    buffer_load_dwordx4 v7, s[68:71], s11 offen offset:1024 lds
    s_waitcnt vmcnt(0)
    v_mov_b32 v26, 1
    ds_write_b32 v15, v26 offset:32
    s_waitcnt lgkmcnt(0)
    s_barrier
    s_branch kf_kernel_rg0
kf_kernel_gr:
    s_add_u32 m0, s15, 150528
    s_nop 0
    buffer_load_dwordx4 v11, s[64:67], s13 offen sc1 lds
    buffer_load_dwordx4 v13, s[64:67], s13 offen offset:1024 sc1 lds
    s_add_u32 s77, s77, 256
    s_cmp_gt_u32 s77, 16777216
    s_waitcnt vmcnt(0)
    s_cbranch_scc1 kf_kernel_gro
    ds_read_b32 v20, v17 offset:0
    ds_read_b32 v21, v17 offset:1024
    s_waitcnt lgkmcnt(0)
    v_max_u32 v20, v20, v21
    v_cmp_eq_u32 vcc, -1, v20
    s_cbranch_vccnz kf_kernel_gr
    s_branch kf_kernel_gro
kf_kernel_idle:
    s_memtime s[76:77]
    s_lshr_b32 s34, s30, 1
    s_lshl_b32 s34, s34, 3
    s_sub_u32 s35, s31, 28
    s_lshl_b32 s35, s35, 1
    s_add_u32 s34, s34, s35
    s_and_b32 s35, s30, 1
    s_add_u32 s54, s34, s35
    s_lshl_b32 s34, s34, 16
    s_lshl_b32 s35, s35, 7
    s_add_u32 s34, s34, s35
    s_lshl_b32 s35, s20, 15
    s_add_u32 s34, s34, s35
    s_add_u32 s34, s34, 0x800000
    v_lshrrev_b32 v13, 3, v1
    v_lshlrev_b32 v13, 8, v13
    v_and_b32 v14, 7, v1
    v_lshl_add_u32 v13, v14, 4, v13
    s_mov_b32 s35, 0
    s_barrier
    s_sleep 8
kf_kernel_ip:
    s_sleep 4
    s_mov_b32 s36, s34
    buffer_load_dwordx4 v[128:131], v13, s[64:67], s36 offen offset:0 sc1
    buffer_load_dwordx4 v[132:135], v13, s[64:67], s36 offen offset:2048 sc1
    s_add_u32 s36, s36, 4096
    buffer_load_dwordx4 v[136:139], v13, s[64:67], s36 offen offset:0 sc1
    buffer_load_dwordx4 v[140:143], v13, s[64:67], s36 offen offset:2048 sc1
    s_add_u32 s36, s36, 4096
    buffer_load_dwordx4 v[144:147], v13, s[64:67], s36 offen offset:0 sc1
    buffer_load_dwordx4 v[148:151], v13, s[64:67], s36 offen offset:2048 sc1
    s_add_u32 s36, s36, 4096
    buffer_load_dwordx4 v[152:155], v13, s[64:67], s36 offen offset:0 sc1
    buffer_load_dwordx4 v[156:159], v13, s[64:67], s36 offen offset:2048 sc1
    s_add_u32 s36, s36, 4096
    buffer_load_dwordx4 v[160:163], v13, s[64:67], s36 offen offset:0 sc1
    buffer_load_dwordx4 v[164:167], v13, s[64:67], s36 offen offset:2048 sc1
    s_add_u32 s36, s36, 4096
    buffer_load_dwordx4 v[168:171], v13, s[64:67], s36 offen offset:0 sc1
    buffer_load_dwordx4 v[172:175], v13, s[64:67], s36 offen offset:2048 sc1
    s_add_u32 s36, s36, 4096
    buffer_load_dwordx4 v[176:179], v13, s[64:67], s36 offen offset:0 sc1
    buffer_load_dwordx4 v[180:183], v13, s[64:67], s36 offen offset:2048 sc1
    s_add_u32 s36, s36, 4096
    buffer_load_dwordx4 v[184:187], v13, s[64:67], s36 offen offset:0 sc1
    buffer_load_dwordx4 v[188:191], v13, s[64:67], s36 offen offset:2048 sc1
    s_add_u32 s36, s36, 4096
    s_add_u32 s35, s35, 1
    s_cmp_gt_u32 s35, 65536
    s_waitcnt vmcnt(0)
    s_cbranch_scc1 kf_kernel_ipo
    v_max_u32 v60, v128, v132
    v_max3_u32 v60, v60, v136, v140
    v_max3_u32 v60, v60, v144, v148
    v_max3_u32 v60, v60, v152, v156
    v_max3_u32 v60, v60, v160, v164
    v_max3_u32 v60, v60, v168, v172
    v_max3_u32 v60, v60, v176, v180
    v_max3_u32 v60, v60, v184, v188
    v_cmp_eq_u32 vcc, -1, v60
    s_cbranch_vccnz kf_kernel_ip
kf_kernel_ipo:
    v_mov_b64 v[64:65], 0
    v_mov_b64 v[66:67], 0
    v_mov_b64 v[68:69], 0
    v_mov_b64 v[70:71], 0
    v_mov_b64 v[72:73], 0
    v_mov_b64 v[74:75], 0
    v_mov_b64 v[76:77], 0
    v_mov_b64 v[78:79], 0
    v_lshlrev_b32 v14, 5, v14
    v_lshl_add_u32 v14, v2, 8, v14
    v_and_b32 v13, 16, v1
    v_add_u32 v14, v14, v13
    s_lshl_b32 s35, s20, 9
    s_add_u32 s35, s35, 98304
    v_add_u32 v14, s35, v14
    v_lshlrev_b32 v80, 16, v128
    v_and_b32 v81, 0xffff0000, v128
    v_lshlrev_b32 v82, 16, v129
    v_and_b32 v83, 0xffff0000, v129
    v_lshlrev_b32 v84, 16, v130
    v_and_b32 v85, 0xffff0000, v130
    v_lshlrev_b32 v86, 16, v131
    v_and_b32 v87, 0xffff0000, v131
    v_pk_add_f32 v[64:65], v[64:65], v[80:81]
    v_pk_fma_f32 v[72:73], v[80:81], v[80:81], v[72:73]
    v_pk_add_f32 v[66:67], v[66:67], v[82:83]
    v_pk_fma_f32 v[74:75], v[82:83], v[82:83], v[74:75]
    v_pk_add_f32 v[68:69], v[68:69], v[84:85]
    v_pk_fma_f32 v[76:77], v[84:85], v[84:85], v[76:77]
    v_pk_add_f32 v[70:71], v[70:71], v[86:87]
    v_pk_fma_f32 v[78:79], v[86:87], v[86:87], v[78:79]
    v_lshlrev_b32 v80, 16, v132
    v_and_b32 v81, 0xffff0000, v132
    v_lshlrev_b32 v82, 16, v133
    v_and_b32 v83, 0xffff0000, v133
    v_lshlrev_b32 v84, 16, v134
    v_and_b32 v85, 0xffff0000, v134
    v_lshlrev_b32 v86, 16, v135
    v_and_b32 v87, 0xffff0000, v135
    v_pk_add_f32 v[64:65], v[64:65], v[80:81]
    v_pk_fma_f32 v[72:73], v[80:81], v[80:81], v[72:73]
    v_pk_add_f32 v[66:67], v[66:67], v[82:83]
    v_pk_fma_f32 v[74:75], v[82:83], v[82:83], v[74:75]
    v_pk_add_f32 v[68:69], v[68:69], v[84:85]
    v_pk_fma_f32 v[76:77], v[84:85], v[84:85], v[76:77]
    v_pk_add_f32 v[70:71], v[70:71], v[86:87]
    v_pk_fma_f32 v[78:79], v[86:87], v[86:87], v[78:79]
    v_lshlrev_b32 v80, 16, v136
    v_and_b32 v81, 0xffff0000, v136
    v_lshlrev_b32 v82, 16, v137
    v_and_b32 v83, 0xffff0000, v137
    v_lshlrev_b32 v84, 16, v138
    v_and_b32 v85, 0xffff0000, v138
    v_lshlrev_b32 v86, 16, v139
    v_and_b32 v87, 0xffff0000, v139
    v_pk_add_f32 v[64:65], v[64:65], v[80:81]
    v_pk_fma_f32 v[72:73], v[80:81], v[80:81], v[72:73]
    v_pk_add_f32 v[66:67], v[66:67], v[82:83]
    v_pk_fma_f32 v[74:75], v[82:83], v[82:83], v[74:75]
    v_pk_add_f32 v[68:69], v[68:69], v[84:85]
    v_pk_fma_f32 v[76:77], v[84:85], v[84:85], v[76:77]
    v_pk_add_f32 v[70:71], v[70:71], v[86:87]
    v_pk_fma_f32 v[78:79], v[86:87], v[86:87], v[78:79]
    v_lshlrev_b32 v80, 16, v140
    v_and_b32 v81, 0xffff0000, v140
    v_lshlrev_b32 v82, 16, v141
    v_and_b32 v83, 0xffff0000, v141
    v_lshlrev_b32 v84, 16, v142
    v_and_b32 v85, 0xffff0000, v142
    v_lshlrev_b32 v86, 16, v143
    v_and_b32 v87, 0xffff0000, v143
    v_pk_add_f32 v[64:65], v[64:65], v[80:81]
    v_pk_fma_f32 v[72:73], v[80:81], v[80:81], v[72:73]
    v_pk_add_f32 v[66:67], v[66:67], v[82:83]
    v_pk_fma_f32 v[74:75], v[82:83], v[82:83], v[74:75]
    v_pk_add_f32 v[68:69], v[68:69], v[84:85]
    v_pk_fma_f32 v[76:77], v[84:85], v[84:85], v[76:77]
    v_pk_add_f32 v[70:71], v[70:71], v[86:87]
    v_pk_fma_f32 v[78:79], v[86:87], v[86:87], v[78:79]
    v_lshlrev_b32 v80, 16, v144
    v_and_b32 v81, 0xffff0000, v144
    v_lshlrev_b32 v82, 16, v145
    v_and_b32 v83, 0xffff0000, v145
    v_lshlrev_b32 v84, 16, v146
    v_and_b32 v85, 0xffff0000, v146
    v_lshlrev_b32 v86, 16, v147
    v_and_b32 v87, 0xffff0000, v147
    v_pk_add_f32 v[64:65], v[64:65], v[80:81]
    v_pk_fma_f32 v[72:73], v[80:81], v[80:81], v[72:73]
    v_pk_add_f32 v[66:67], v[66:67], v[82:83]
    v_pk_fma_f32 v[74:75], v[82:83], v[82:83], v[74:75]
    v_pk_add_f32 v[68:69], v[68:69], v[84:85]
    v_pk_fma_f32 v[76:77], v[84:85], v[84:85], v[76:77]
    v_pk_add_f32 v[70:71], v[70:71], v[86:87]
    v_pk_fma_f32 v[78:79], v[86:87], v[86:87], v[78:79]
    v_lshlrev_b32 v80, 16, v148
    v_and_b32 v81, 0xffff0000, v148
    v_lshlrev_b32 v82, 16, v149
    v_and_b32 v83, 0xffff0000, v149
    v_lshlrev_b32 v84, 16, v150
    v_and_b32 v85, 0xffff0000, v150
    v_lshlrev_b32 v86, 16, v151
    v_and_b32 v87, 0xffff0000, v151
    v_pk_add_f32 v[64:65], v[64:65], v[80:81]
    v_pk_fma_f32 v[72:73], v[80:81], v[80:81], v[72:73]
    v_pk_add_f32 v[66:67], v[66:67], v[82:83]
    v_pk_fma_f32 v[74:75], v[82:83], v[82:83], v[74:75]
    v_pk_add_f32 v[68:69], v[68:69], v[84:85]
    v_pk_fma_f32 v[76:77], v[84:85], v[84:85], v[76:77]
    v_pk_add_f32 v[70:71], v[70:71], v[86:87]
    v_pk_fma_f32 v[78:79], v[86:87], v[86:87], v[78:79]
    v_lshlrev_b32 v80, 16, v152
    v_and_b32 v81, 0xffff0000, v152
    v_lshlrev_b32 v82, 16, v153
    v_and_b32 v83, 0xffff0000, v153
    v_lshlrev_b32 v84, 16, v154
    v_and_b32 v85, 0xffff0000, v154
    v_lshlrev_b32 v86, 16, v155
    v_and_b32 v87, 0xffff0000, v155
    v_pk_add_f32 v[64:65], v[64:65], v[80:81]
    v_pk_fma_f32 v[72:73], v[80:81], v[80:81], v[72:73]
    v_pk_add_f32 v[66:67], v[66:67], v[82:83]
    v_pk_fma_f32 v[74:75], v[82:83], v[82:83], v[74:75]
    v_pk_add_f32 v[68:69], v[68:69], v[84:85]
    v_pk_fma_f32 v[76:77], v[84:85], v[84:85], v[76:77]
    v_pk_add_f32 v[70:71], v[70:71], v[86:87]
    v_pk_fma_f32 v[78:79], v[86:87], v[86:87], v[78:79]
    v_lshlrev_b32 v80, 16, v156
    v_and_b32 v81, 0xffff0000, v156
    v_lshlrev_b32 v82, 16, v157
    v_and_b32 v83, 0xffff0000, v157
    v_lshlrev_b32 v84, 16, v158
    v_and_b32 v85, 0xffff0000, v158
    v_lshlrev_b32 v86, 16, v159
    v_and_b32 v87, 0xffff0000, v159
    v_pk_add_f32 v[64:65], v[64:65], v[80:81]
    v_pk_fma_f32 v[72:73], v[80:81], v[80:81], v[72:73]
    v_pk_add_f32 v[66:67], v[66:67], v[82:83]
    v_pk_fma_f32 v[74:75], v[82:83], v[82:83], v[74:75]
    v_pk_add_f32 v[68:69], v[68:69], v[84:85]
    v_pk_fma_f32 v[76:77], v[84:85], v[84:85], v[76:77]
    v_pk_add_f32 v[70:71], v[70:71], v[86:87]
    v_pk_fma_f32 v[78:79], v[86:87], v[86:87], v[78:79]
    v_lshlrev_b32 v80, 16, v160
    v_and_b32 v81, 0xffff0000, v160
    v_lshlrev_b32 v82, 16, v161
    v_and_b32 v83, 0xffff0000, v161
    v_lshlrev_b32 v84, 16, v162
    v_and_b32 v85, 0xffff0000, v162
    v_lshlrev_b32 v86, 16, v163
    v_and_b32 v87, 0xffff0000, v163
    v_pk_add_f32 v[64:65], v[64:65], v[80:81]
    v_pk_fma_f32 v[72:73], v[80:81], v[80:81], v[72:73]
    v_pk_add_f32 v[66:67], v[66:67], v[82:83]
    v_pk_fma_f32 v[74:75], v[82:83], v[82:83], v[74:75]
    v_pk_add_f32 v[68:69], v[68:69], v[84:85]
    v_pk_fma_f32 v[76:77], v[84:85], v[84:85], v[76:77]
    v_pk_add_f32 v[70:71], v[70:71], v[86:87]
    v_pk_fma_f32 v[78:79], v[86:87], v[86:87], v[78:79]
    v_lshlrev_b32 v80, 16, v164
    v_and_b32 v81, 0xffff0000, v164
    v_lshlrev_b32 v82, 16, v165
    v_and_b32 v83, 0xffff0000, v165
    v_lshlrev_b32 v84, 16, v166
    v_and_b32 v85, 0xffff0000, v166
    v_lshlrev_b32 v86, 16, v167
    v_and_b32 v87, 0xffff0000, v167
    v_pk_add_f32 v[64:65], v[64:65], v[80:81]
    v_pk_fma_f32 v[72:73], v[80:81], v[80:81], v[72:73]
    v_pk_add_f32 v[66:67], v[66:67], v[82:83]
    v_pk_fma_f32 v[74:75], v[82:83], v[82:83], v[74:75]
    v_pk_add_f32 v[68:69], v[68:69], v[84:85]
    v_pk_fma_f32 v[76:77], v[84:85], v[84:85], v[76:77]
    v_pk_add_f32 v[70:71], v[70:71], v[86:87]
    v_pk_fma_f32 v[78:79], v[86:87], v[86:87], v[78:79]
    v_lshlrev_b32 v80, 16, v168
    v_and_b32 v81, 0xffff0000, v168
    v_lshlrev_b32 v82, 16, v169
    v_and_b32 v83, 0xffff0000, v169
    v_lshlrev_b32 v84, 16, v170
    v_and_b32 v85, 0xffff0000, v170
    v_lshlrev_b32 v86, 16, v171
    v_and_b32 v87, 0xffff0000, v171
    v_pk_add_f32 v[64:65], v[64:65], v[80:81]
    v_pk_fma_f32 v[72:73], v[80:81], v[80:81], v[72:73]
    v_pk_add_f32 v[66:67], v[66:67], v[82:83]
    v_pk_fma_f32 v[74:75], v[82:83], v[82:83], v[74:75]
    v_pk_add_f32 v[68:69], v[68:69], v[84:85]
    v_pk_fma_f32 v[76:77], v[84:85], v[84:85], v[76:77]
    v_pk_add_f32 v[70:71], v[70:71], v[86:87]
    v_pk_fma_f32 v[78:79], v[86:87], v[86:87], v[78:79]
    v_lshlrev_b32 v80, 16, v172
    v_and_b32 v81, 0xffff0000, v172
    v_lshlrev_b32 v82, 16, v173
    v_and_b32 v83, 0xffff0000, v173
    v_lshlrev_b32 v84, 16, v174
    v_and_b32 v85, 0xffff0000, v174
    v_lshlrev_b32 v86, 16, v175
    v_and_b32 v87, 0xffff0000, v175
    v_pk_add_f32 v[64:65], v[64:65], v[80:81]
    v_pk_fma_f32 v[72:73], v[80:81], v[80:81], v[72:73]
    v_pk_add_f32 v[66:67], v[66:67], v[82:83]
    v_pk_fma_f32 v[74:75], v[82:83], v[82:83], v[74:75]
    v_pk_add_f32 v[68:69], v[68:69], v[84:85]
    v_pk_fma_f32 v[76:77], v[84:85], v[84:85], v[76:77]
    v_pk_add_f32 v[70:71], v[70:71], v[86:87]
    v_pk_fma_f32 v[78:79], v[86:87], v[86:87], v[78:79]
    v_lshlrev_b32 v80, 16, v176
    v_and_b32 v81, 0xffff0000, v176
    v_lshlrev_b32 v82, 16, v177
    v_and_b32 v83, 0xffff0000, v177
    v_lshlrev_b32 v84, 16, v178
    v_and_b32 v85, 0xffff0000, v178
    v_lshlrev_b32 v86, 16, v179
    v_and_b32 v87, 0xffff0000, v179
    v_pk_add_f32 v[64:65], v[64:65], v[80:81]
    v_pk_fma_f32 v[72:73], v[80:81], v[80:81], v[72:73]
    v_pk_add_f32 v[66:67], v[66:67], v[82:83]
    v_pk_fma_f32 v[74:75], v[82:83], v[82:83], v[74:75]
    v_pk_add_f32 v[68:69], v[68:69], v[84:85]
    v_pk_fma_f32 v[76:77], v[84:85], v[84:85], v[76:77]
    v_pk_add_f32 v[70:71], v[70:71], v[86:87]
    v_pk_fma_f32 v[78:79], v[86:87], v[86:87], v[78:79]
    v_lshlrev_b32 v80, 16, v180
    v_and_b32 v81, 0xffff0000, v180
    v_lshlrev_b32 v82, 16, v181
    v_and_b32 v83, 0xffff0000, v181
    v_lshlrev_b32 v84, 16, v182
    v_and_b32 v85, 0xffff0000, v182
    v_lshlrev_b32 v86, 16, v183
    v_and_b32 v87, 0xffff0000, v183
    v_pk_add_f32 v[64:65], v[64:65], v[80:81]
    v_pk_fma_f32 v[72:73], v[80:81], v[80:81], v[72:73]
    v_pk_add_f32 v[66:67], v[66:67], v[82:83]
    v_pk_fma_f32 v[74:75], v[82:83], v[82:83], v[74:75]
    v_pk_add_f32 v[68:69], v[68:69], v[84:85]
    v_pk_fma_f32 v[76:77], v[84:85], v[84:85], v[76:77]
    v_pk_add_f32 v[70:71], v[70:71], v[86:87]
    v_pk_fma_f32 v[78:79], v[86:87], v[86:87], v[78:79]
    v_lshlrev_b32 v80, 16, v184
    v_and_b32 v81, 0xffff0000, v184
    v_lshlrev_b32 v82, 16, v185
    v_and_b32 v83, 0xffff0000, v185
    v_lshlrev_b32 v84, 16, v186
    v_and_b32 v85, 0xffff0000, v186
    v_lshlrev_b32 v86, 16, v187
    v_and_b32 v87, 0xffff0000, v187
    v_pk_add_f32 v[64:65], v[64:65], v[80:81]
    v_pk_fma_f32 v[72:73], v[80:81], v[80:81], v[72:73]
    v_pk_add_f32 v[66:67], v[66:67], v[82:83]
    v_pk_fma_f32 v[74:75], v[82:83], v[82:83], v[74:75]
    v_pk_add_f32 v[68:69], v[68:69], v[84:85]
    v_pk_fma_f32 v[76:77], v[84:85], v[84:85], v[76:77]
    v_pk_add_f32 v[70:71], v[70:71], v[86:87]
    v_pk_fma_f32 v[78:79], v[86:87], v[86:87], v[78:79]
    v_lshlrev_b32 v80, 16, v188
    v_and_b32 v81, 0xffff0000, v188
    v_lshlrev_b32 v82, 16, v189
    v_and_b32 v83, 0xffff0000, v189
    v_lshlrev_b32 v84, 16, v190
    v_and_b32 v85, 0xffff0000, v190
    v_lshlrev_b32 v86, 16, v191
    v_and_b32 v87, 0xffff0000, v191
    v_pk_add_f32 v[64:65], v[64:65], v[80:81]
    v_pk_fma_f32 v[72:73], v[80:81], v[80:81], v[72:73]
    v_pk_add_f32 v[66:67], v[66:67], v[82:83]
    v_pk_fma_f32 v[74:75], v[82:83], v[82:83], v[74:75]
    v_pk_add_f32 v[68:69], v[68:69], v[84:85]
    v_pk_fma_f32 v[76:77], v[84:85], v[84:85], v[76:77]
    v_pk_add_f32 v[70:71], v[70:71], v[86:87]
    v_pk_fma_f32 v[78:79], v[86:87], v[86:87], v[78:79]
    s_nop 1
    v_permlane32_swap_b32 v64, v72
    v_permlane32_swap_b32 v65, v73
    v_permlane32_swap_b32 v66, v74
    v_permlane32_swap_b32 v67, v75
    v_permlane32_swap_b32 v68, v76
    v_permlane32_swap_b32 v69, v77
    v_permlane32_swap_b32 v70, v78
    v_permlane32_swap_b32 v71, v79
    v_pk_add_f32 v[64:65], v[64:65], v[72:73]
    v_pk_add_f32 v[66:67], v[66:67], v[74:75]
    v_pk_add_f32 v[68:69], v[68:69], v[76:77]
    v_pk_add_f32 v[70:71], v[70:71], v[78:79]
    s_nop 1
    v_permlane16_swap_b32 v64, v68
    v_permlane16_swap_b32 v65, v69
    v_permlane16_swap_b32 v66, v70
    v_permlane16_swap_b32 v67, v71
    v_pk_add_f32 v[64:65], v[64:65], v[68:69]
    v_pk_add_f32 v[66:67], v[66:67], v[70:71]
    s_nop 1
    v_add_f32_dpp v64, v64, v64 row_ror:8 row_mask:0xf bank_mask:0xf
    v_add_f32_dpp v65, v65, v65 row_ror:8 row_mask:0xf bank_mask:0xf
    v_add_f32_dpp v66, v66, v66 row_ror:8 row_mask:0xf bank_mask:0xf
    v_add_f32_dpp v67, v67, v67 row_ror:8 row_mask:0xf bank_mask:0xf
    ds_write_b128 v14, v[64:67]
    v_mov_b32 v14, 1
    ds_write_b32 v11, v14 offset:32
    s_cmp_lg_u32 s20, 0
    s_cbranch_scc1 kf_kernel_isd
    s_mov_b32 s35, 0
kf_kernel_isp:
    ds_read_b128 v[60:63], v126 offset:64
    s_add_u32 s35, s35, 1
    s_cmp_gt_u32 s35, 65536
    s_cbranch_scc1 kf_kernel_ispo
    s_waitcnt lgkmcnt(0)
    v_min_u32 v60, v60, v61
    v_min3_u32 v60, v60, v62, v63
    v_cmp_eq_u32 vcc, 0, v60
    s_cbranch_vccnz kf_kernel_isp
kf_kernel_ispo:
    v_lshlrev_b32 v13, 2, v1
    v_add_u32 v13, 98304, v13
    ds_read_b32 v80, v13 offset:0
    ds_read_b32 v81, v13 offset:512
    ds_read_b32 v82, v13 offset:1024
    ds_read_b32 v83, v13 offset:1536
    ds_read_b32 v84, v13 offset:256
    ds_read_b32 v85, v13 offset:768
    ds_read_b32 v86, v13 offset:1280
    ds_read_b32 v87, v13 offset:1792
    s_waitcnt lgkmcnt(0)
    v_add_f32 v80, v80, v81
    v_add_f32 v82, v82, v83
    v_add_f32 v84, v84, v85
    v_add_f32 v86, v86, v87
    v_add_f32 v80, v80, v82
    v_add_f32 v84, v84, v86
    v_mul_f32 v80, 0x3b000000, v80
    v_mul_f32 v84, 0x3b000000, v84
    v_fma_f32 v80, -v80, v80, v84
    v_max_f32 v80, 0, v80
    v_cvt_pk_bf16_f32 v80, v80, v80
    v_and_b32 v80, 0xffff0000, v80
    v_add_f32 v80, 0x3727c5ac, v80
    v_cvt_pk_bf16_f32 v80, v80, v80
    v_and_b32 v80, 0xffff0000, v80
    v_sqrt_f32 v80, v80
    s_nop 0
    v_cvt_pk_bf16_f32 v80, v80, v80
    v_and_b32 v80, 0xffff0000, v80
    v_rcp_f32 v80, v80
    s_nop 0
    ds_write_b32 v13, v80
    v_lshlrev_b32 v14, 4, v1
    v_add_u32 v13, 98304, v14
    s_lshl_b32 s35, s54, 8
    s_add_u32 s35, s35, 0x1110000
    s_lshl_b32 s36, s54, 13
    s_add_u32 s36, s36, 0x11c0800
    s_mov_b64 exec, 0xffff
    ds_read_b128 v[80:83], v13
    s_waitcnt lgkmcnt(0)
    buffer_store_dwordx4 v[80:83], v14, s[64:67], s35 offen sc1
    s_mov_b64 exec, 1
    v_mov_b32 v14, 0
    s_waitcnt vmcnt(0)
    buffer_store_dword v59, v14, s[64:67], s36 offen sc1
    s_mov_b64 exec, -1
kf_kernel_isd:
    s_mov_b32 s35, 0
kf_kernel_ics2:
    ds_read_b32 v60, v125
    s_add_u32 s35, s35, 1
    s_cmp_gt_u32 s35, 65536
    s_cbranch_scc1 kf_kernel_ics2o
    s_waitcnt lgkmcnt(0)
    v_cmp_gt_u32 vcc, 2, v60
    s_cbranch_vccnz kf_kernel_ics2
kf_kernel_ics2o:
    ds_read_b64_tr_b16 v[128:129], v114 offset:0
    ds_read_b64_tr_b16 v[130:131], v114 offset:1024
    ds_read_b64_tr_b16 v[132:133], v115 offset:0
    ds_read_b64_tr_b16 v[134:135], v115 offset:1024
    ds_read_b64_tr_b16 v[136:137], v114 offset:2048
    ds_read_b64_tr_b16 v[138:139], v114 offset:3072
    ds_read_b64_tr_b16 v[140:141], v115 offset:2048
    ds_read_b64_tr_b16 v[142:143], v115 offset:3072
    ds_read_b64_tr_b16 v[144:145], v114 offset:4096
    ds_read_b64_tr_b16 v[146:147], v114 offset:5120
    ds_read_b64_tr_b16 v[148:149], v115 offset:4096
    ds_read_b64_tr_b16 v[150:151], v115 offset:5120
    s_waitcnt lgkmcnt(3)
    ds_read_b64_tr_b16 v[152:153], v114 offset:6144
    ds_read_b64_tr_b16 v[154:155], v114 offset:7168
    ds_read_b64_tr_b16 v[156:157], v115 offset:6144
    ds_read_b64_tr_b16 v[158:159], v115 offset:7168
    ds_read_b64_tr_b16 v[160:161], v116 offset:0
    ds_read_b64_tr_b16 v[162:163], v116 offset:1024
    ds_read_b64_tr_b16 v[164:165], v117 offset:0
    ds_read_b64_tr_b16 v[166:167], v117 offset:1024
    ds_read_b64_tr_b16 v[168:169], v116 offset:2048
    ds_read_b64_tr_b16 v[170:171], v116 offset:3072
    ds_read_b64_tr_b16 v[172:173], v117 offset:2048
    ds_read_b64_tr_b16 v[174:175], v117 offset:3072
    s_waitcnt lgkmcnt(3)
    ds_read_b64_tr_b16 v[176:177], v116 offset:4096
    ds_read_b64_tr_b16 v[178:179], v116 offset:5120
    ds_read_b64_tr_b16 v[180:181], v117 offset:4096
    ds_read_b64_tr_b16 v[182:183], v117 offset:5120
    ds_read_b64_tr_b16 v[184:185], v116 offset:6144
    ds_read_b64_tr_b16 v[186:187], v116 offset:7168
    ds_read_b64_tr_b16 v[188:189], v117 offset:6144
    ds_read_b64_tr_b16 v[190:191], v117 offset:7168
    v_bfe_u32 v60, v1, 2, 2
    v_min_u32 v60, 1, v60
    v_lshlrev_b32 v60, 3, v60
    s_lshl_b32 s36, s60, 2
    s_add_u32 s35, s36, 3
    v_add_u32 v60, s35, v60
    s_sub_u32 s36, 27, s36
    v_min_u32 v60, s36, v60
    v_and_b32 v61, 7, v1
    v_lshlrev_b32 v61, 4, v61
    v_lshl_add_u32 v13, v60, 10, v61
    v_add_u32 v13, 896, v13
    v_bfe_u32 v60, v1, 4, 1
    v_mul_u32_u24 v60, 114688, v60
    v_add_u32 v13, v13, v60
    v_mov_b32 v14, 3
    s_waitcnt lgkmcnt(0)
    ds_write_b32 v11, v14
    s_mov_b32 exec_hi, 0
    s_mov_b32 s35, 0
kf_kernel_iw:
    s_memtime s[78:79]
    s_add_u32 s35, s35, 1
    s_waitcnt lgkmcnt(0)
    s_sub_u32 s78, s78, s76
    s_cmp_ge_u32 s78, 9000
    s_cbranch_scc1 kf_kernel_iwo
    s_sleep 2
    s_cmp_lt_u32 s35, 256
    s_cbranch_scc1 kf_kernel_iw
kf_kernel_iwo:
    s_lshr_b32 s36, s8, 1
    s_lshl_b32 s36, s36, 14
    s_add_u32 s36, s36, 0x11c1000
    v_lshlrev_b32 v60, 6, v1
    s_mov_b64 exec, 0x3fff
    s_mov_b32 s35, 0
    s_branch kf_kernel_pg1
kf_kernel_pg0:
    s_sleep 8
kf_kernel_pg1:
    buffer_load_dword v61, v60, s[64:67], s36 offen sc1
    s_add_u32 s35, s35, 1
    s_cmp_gt_u32 s35, 65536
    s_cbranch_scc1 kf_kernel_cgot
    s_waitcnt vmcnt(0)
    v_cmp_ne_u32 vcc, s21, v61
    s_cbranch_vccnz kf_kernel_pg0
    s_branch kf_kernel_cgot
kf_kernel_cspin:
    s_sleep 8
kf_kernel_csp1:
    buffer_load_dwordx4 v[56:59], v13, s[64:67], s48 offen sc1
    s_add_u32 s35, s35, 1
    s_cmp_gt_u32 s35, 65536
    s_cbranch_scc1 kf_kernel_cgot
    s_waitcnt vmcnt(0)
    v_xor_b32 v56, v56, v112
    v_xor_b32 v58, v58, v113
    v_or_b32 v56, v56, v58
    v_and_b32 v56, 0x80008000, v56
    v_cmp_ne_u32 vcc, 0, v56
    s_cbranch_vccnz kf_kernel_cspin
kf_kernel_cgot:
    s_mov_b64 exec, -1
    s_add_u32 s42, s45, 0
    s_add_u32 s43, s46, 0
    buffer_load_dwordx4 v[80:83], v9, s[64:67], s42 offen offset:0 sc1
    buffer_load_dwordx4 v[84:87], v9, s[64:67], s43 offen offset:0 sc1
    buffer_load_dwordx4 v[88:91], v9, s[64:67], s42 offen offset:1024 sc1
    buffer_load_dwordx4 v[92:95], v9, s[64:67], s43 offen offset:1024 sc1
    buffer_load_dwordx4 v[96:99], v9, s[64:67], s42 offen offset:2048 sc1
    buffer_load_dwordx4 v[100:103], v9, s[64:67], s43 offen offset:2048 sc1
    buffer_load_dwordx4 v[104:107], v9, s[64:67], s42 offen offset:3072 sc1
    buffer_load_dwordx4 v[108:111], v9, s[64:67], s43 offen offset:3072 sc1
    s_add_u32 s42, s45, 8192
    s_add_u32 s43, s46, 8192
    buffer_load_dwordx4 v[24:27], v9, s[64:67], s42 offen offset:0 sc1
    buffer_load_dwordx4 v[28:31], v9, s[64:67], s43 offen offset:0 sc1
    buffer_load_dwordx4 v[32:35], v9, s[64:67], s42 offen offset:1024 sc1
    buffer_load_dwordx4 v[36:39], v9, s[64:67], s43 offen offset:1024 sc1
    buffer_load_dwordx4 v[40:43], v9, s[64:67], s42 offen offset:2048 sc1
    buffer_load_dwordx4 v[44:47], v9, s[64:67], s43 offen offset:2048 sc1
    buffer_load_dwordx4 v[48:51], v9, s[64:67], s42 offen offset:3072 sc1
    buffer_load_dwordx4 v[52:55], v9, s[64:67], s43 offen offset:3072 sc1
    buffer_load_dword v57, v9, s[64:67], s42 offen
    buffer_load_dword v58, v9, s[64:67], s42 offen
    s_branch kf_kernel_cskip
kf_kernel_csr:
    s_sleep 4
    buffer_load_dwordx2 v[40:41], v13, s[64:67], s38 offen sc1
    buffer_load_dwordx2 v[42:43], v13, s[64:67], s39 offen sc1
    buffer_load_dwordx2 v[44:45], v13, s[64:67], s40 offen sc1
    buffer_load_dwordx2 v[46:47], v13, s[64:67], s41 offen sc1
    s_add_u32 s54, s54, 1
    s_cmp_gt_u32 s54, 65536
    s_cbranch_scc1 kf_kernel_csok
    s_waitcnt vmcnt(0)
    v_xor_b32 v41, s21, v41
    v_xor_b32 v43, s21, v43
    v_xor_b32 v45, s21, v45
    v_xor_b32 v47, s21, v47
    v_or3_b32 v41, v41, v43, v45
    v_or_b32 v41, v41, v47
    v_cmp_ne_u32 vcc, 0, v41
    s_cbranch_vccnz kf_kernel_csr
    s_branch kf_kernel_csok
kf_kernel_nf:
    s_cmp_ge_u32 s63, 2000
    s_cbranch_scc1 kf_kernel_nfb
    v_mov_b32 v15, 1
    ds_write_b32 v126, v15 offset:88
    s_waitcnt lgkmcnt(0)
    s_branch kf_kernel_nfb
kf_kernel_cre:
    s_add_u32 s63, s63, 1
    s_waitcnt vmcnt(0) lgkmcnt(0)
    s_barrier
    s_barrier
    s_branch kf_kernel_rpt
kf_kernel_cs2s:
    s_mov_b32 s35, 0
kf_kernel_cs2:
    ds_read_b128 v[16:19], v126 offset:48
    s_add_u32 s35, s35, 1
    s_cmp_gt_u32 s35, 65536
    s_cbranch_scc1 kf_kernel_cs2o
    s_waitcnt lgkmcnt(0)
    v_min_u32 v16, v16, v17
    v_min3_u32 v16, v16, v18, v19
    v_cmp_gt_u32 vcc, 2, v16
    s_cbranch_vccnz kf_kernel_cs2
kf_kernel_cs2o:
    s_branch kf_kernel_cs2b
kf_kernel_hr0:
    s_sleep 2
    s_add_u32 s35, s45, 0
    s_add_u32 s36, s46, 0
    buffer_load_dwordx4 v[80:83], v9, s[64:67], s35 offen offset:0 sc1
    buffer_load_dwordx4 v[84:87], v9, s[64:67], s36 offen offset:0 sc1
    buffer_load_dwordx4 v[88:91], v9, s[64:67], s35 offen offset:1024 sc1
    buffer_load_dwordx4 v[92:95], v9, s[64:67], s36 offen offset:1024 sc1
    buffer_load_dwordx4 v[96:99], v9, s[64:67], s35 offen offset:2048 sc1
    buffer_load_dwordx4 v[100:103], v9, s[64:67], s36 offen offset:2048 sc1
    buffer_load_dwordx4 v[104:107], v9, s[64:67], s35 offen offset:3072 sc1
    buffer_load_dwordx4 v[108:111], v9, s[64:67], s36 offen offset:3072 sc1
    s_add_u32 s47, s47, 1
    s_cmp_gt_u32 s47, 65536
    s_cbranch_scc1 kf_kernel_hk0
    s_waitcnt vmcnt(0)
    v_xor_b32 v80, v80, v112
    v_xor_b32 v82, v82, v113
    v_xor_b32 v84, v84, v112
    v_xor_b32 v86, v86, v113
    v_or3_b32 v56, v80, v82, v84
    v_or_b32 v56, v56, v86
    v_and_b32 v56, 0x80008000, v56
    v_cmp_ne_u32 vcc, 0, v56
    s_cbranch_vccnz kf_kernel_hr0
    s_nop 0
    s_branch kf_kernel_hk0
kf_kernel_hr1:
    s_sleep 2
    s_add_u32 s35, s45, 0
    s_add_u32 s36, s46, 0
    buffer_load_dwordx4 v[88:91], v9, s[64:67], s35 offen offset:1024 sc1
    buffer_load_dwordx4 v[92:95], v9, s[64:67], s36 offen offset:1024 sc1
    buffer_load_dwordx4 v[96:99], v9, s[64:67], s35 offen offset:2048 sc1
    buffer_load_dwordx4 v[100:103], v9, s[64:67], s36 offen offset:2048 sc1
    buffer_load_dwordx4 v[104:107], v9, s[64:67], s35 offen offset:3072 sc1
    buffer_load_dwordx4 v[108:111], v9, s[64:67], s36 offen offset:3072 sc1
    s_add_u32 s35, s45, 8192
    s_add_u32 s36, s46, 8192
    buffer_load_dwordx4 v[24:27], v9, s[64:67], s35 offen offset:0 sc1
    buffer_load_dwordx4 v[28:31], v9, s[64:67], s36 offen offset:0 sc1
    s_add_u32 s47, s47, 1
    s_cmp_gt_u32 s47, 65536
    s_cbranch_scc1 kf_kernel_hk1
    s_waitcnt vmcnt(0)
    v_xor_b32 v88, v88, v112
    v_xor_b32 v90, v90, v113
    v_xor_b32 v92, v92, v112
    v_xor_b32 v94, v94, v113
    v_or3_b32 v56, v88, v90, v92
    v_or_b32 v56, v56, v94
    v_and_b32 v56, 0x80008000, v56
    v_cmp_ne_u32 vcc, 0, v56
    s_cbranch_vccnz kf_kernel_hr1
    s_nop 0
    s_branch kf_kernel_hk1
kf_kernel_hr2:
    s_sleep 2
    s_add_u32 s35, s45, 0
    s_add_u32 s36, s46, 0
    buffer_load_dwordx4 v[96:99], v9, s[64:67], s35 offen offset:2048 sc1
    buffer_load_dwordx4 v[100:103], v9, s[64:67], s36 offen offset:2048 sc1
    buffer_load_dwordx4 v[104:107], v9, s[64:67], s35 offen offset:3072 sc1
    buffer_load_dwordx4 v[108:111], v9, s[64:67], s36 offen offset:3072 sc1
    s_add_u32 s35, s45, 8192
    s_add_u32 s36, s46, 8192
    buffer_load_dwordx4 v[24:27], v9, s[64:67], s35 offen offset:0 sc1
    buffer_load_dwordx4 v[28:31], v9, s[64:67], s36 offen offset:0 sc1
    buffer_load_dwordx4 v[32:35], v9, s[64:67], s35 offen offset:1024 sc1
    buffer_load_dwordx4 v[36:39], v9, s[64:67], s36 offen offset:1024 sc1
    s_add_u32 s47, s47, 1
    s_cmp_gt_u32 s47, 65536
    s_cbranch_scc1 kf_kernel_hk2
    s_waitcnt vmcnt(0)
    v_xor_b32 v96, v96, v112
    v_xor_b32 v98, v98, v113
    v_xor_b32 v100, v100, v112
    v_xor_b32 v102, v102, v113
    v_or3_b32 v56, v96, v98, v100
    v_or_b32 v56, v56, v102
    v_and_b32 v56, 0x80008000, v56
    v_cmp_ne_u32 vcc, 0, v56
    s_cbranch_vccnz kf_kernel_hr2
    s_nop 0
    s_branch kf_kernel_hk2
kf_kernel_hr3:
    s_sleep 2
    s_add_u32 s35, s45, 0
    s_add_u32 s36, s46, 0
    buffer_load_dwordx4 v[104:107], v9, s[64:67], s35 offen offset:3072 sc1
    buffer_load_dwordx4 v[108:111], v9, s[64:67], s36 offen offset:3072 sc1
    s_add_u32 s35, s45, 8192
    s_add_u32 s36, s46, 8192
    buffer_load_dwordx4 v[24:27], v9, s[64:67], s35 offen offset:0 sc1
    buffer_load_dwordx4 v[28:31], v9, s[64:67], s36 offen offset:0 sc1
    buffer_load_dwordx4 v[32:35], v9, s[64:67], s35 offen offset:1024 sc1
    buffer_load_dwordx4 v[36:39], v9, s[64:67], s36 offen offset:1024 sc1
    buffer_load_dwordx4 v[40:43], v9, s[64:67], s35 offen offset:2048 sc1
    buffer_load_dwordx4 v[44:47], v9, s[64:67], s36 offen offset:2048 sc1
    s_add_u32 s47, s47, 1
    s_cmp_gt_u32 s47, 65536
    s_cbranch_scc1 kf_kernel_hk3
    s_waitcnt vmcnt(0)
    v_xor_b32 v104, v104, v112
    v_xor_b32 v106, v106, v113
    v_xor_b32 v108, v108, v112
    v_xor_b32 v110, v110, v113
    v_or3_b32 v56, v104, v106, v108
    v_or_b32 v56, v56, v110
    v_and_b32 v56, 0x80008000, v56
    v_cmp_ne_u32 vcc, 0, v56
    s_cbranch_vccnz kf_kernel_hr3
    s_nop 0
    s_branch kf_kernel_hk3
kf_kernel_hr4:
    s_sleep 2
    s_add_u32 s35, s45, 8192
    s_add_u32 s36, s46, 8192
    buffer_load_dwordx4 v[24:27], v9, s[64:67], s35 offen offset:0 sc1
    buffer_load_dwordx4 v[28:31], v9, s[64:67], s36 offen offset:0 sc1
    buffer_load_dwordx4 v[32:35], v9, s[64:67], s35 offen offset:1024 sc1
    buffer_load_dwordx4 v[36:39], v9, s[64:67], s36 offen offset:1024 sc1
    buffer_load_dwordx4 v[40:43], v9, s[64:67], s35 offen offset:2048 sc1
    buffer_load_dwordx4 v[44:47], v9, s[64:67], s36 offen offset:2048 sc1
    buffer_load_dwordx4 v[48:51], v9, s[64:67], s35 offen offset:3072 sc1
    buffer_load_dwordx4 v[52:55], v9, s[64:67], s36 offen offset:3072 sc1
    s_add_u32 s47, s47, 1
    s_cmp_gt_u32 s47, 65536
    s_cbranch_scc1 kf_kernel_hk4
    s_waitcnt vmcnt(0)
    v_xor_b32 v24, v24, v112
    v_xor_b32 v26, v26, v113
    v_xor_b32 v28, v28, v112
    v_xor_b32 v30, v30, v113
    v_or3_b32 v56, v24, v26, v28
    v_or_b32 v56, v56, v30
    v_and_b32 v56, 0x80008000, v56
    v_cmp_ne_u32 vcc, 0, v56
    s_cbranch_vccnz kf_kernel_hr4
    s_nop 0
    s_branch kf_kernel_hk4
kf_kernel_hr5:
    s_sleep 2
    s_add_u32 s35, s45, 8192
    s_add_u32 s36, s46, 8192
    buffer_load_dwordx4 v[32:35], v9, s[64:67], s35 offen offset:1024 sc1
    buffer_load_dwordx4 v[36:39], v9, s[64:67], s36 offen offset:1024 sc1
    buffer_load_dwordx4 v[40:43], v9, s[64:67], s35 offen offset:2048 sc1
    buffer_load_dwordx4 v[44:47], v9, s[64:67], s36 offen offset:2048 sc1
    buffer_load_dwordx4 v[48:51], v9, s[64:67], s35 offen offset:3072 sc1
    buffer_load_dwordx4 v[52:55], v9, s[64:67], s36 offen offset:3072 sc1
    s_add_u32 s35, s45, 16384
    s_add_u32 s36, s46, 16384
    buffer_load_dwordx4 v[80:83], v9, s[64:67], s35 offen offset:0 sc1
    buffer_load_dwordx4 v[84:87], v9, s[64:67], s36 offen offset:0 sc1
    s_add_u32 s47, s47, 1
    s_cmp_gt_u32 s47, 65536
    s_cbranch_scc1 kf_kernel_hk5
    s_waitcnt vmcnt(0)
    v_xor_b32 v32, v32, v112
    v_xor_b32 v34, v34, v113
    v_xor_b32 v36, v36, v112
    v_xor_b32 v38, v38, v113
    v_or3_b32 v56, v32, v34, v36
    v_or_b32 v56, v56, v38
    v_and_b32 v56, 0x80008000, v56
    v_cmp_ne_u32 vcc, 0, v56
    s_cbranch_vccnz kf_kernel_hr5
    s_nop 0
    s_branch kf_kernel_hk5
kf_kernel_hr6:
    s_sleep 2
    s_add_u32 s35, s45, 8192
    s_add_u32 s36, s46, 8192
    buffer_load_dwordx4 v[40:43], v9, s[64:67], s35 offen offset:2048 sc1
    buffer_load_dwordx4 v[44:47], v9, s[64:67], s36 offen offset:2048 sc1
    buffer_load_dwordx4 v[48:51], v9, s[64:67], s35 offen offset:3072 sc1
    buffer_load_dwordx4 v[52:55], v9, s[64:67], s36 offen offset:3072 sc1
    s_add_u32 s35, s45, 16384
    s_add_u32 s36, s46, 16384
    buffer_load_dwordx4 v[80:83], v9, s[64:67], s35 offen offset:0 sc1
    buffer_load_dwordx4 v[84:87], v9, s[64:67], s36 offen offset:0 sc1
    buffer_load_dwordx4 v[88:91], v9, s[64:67], s35 offen offset:1024 sc1
    buffer_load_dwordx4 v[92:95], v9, s[64:67], s36 offen offset:1024 sc1
    s_add_u32 s47, s47, 1
    s_cmp_gt_u32 s47, 65536
    s_cbranch_scc1 kf_kernel_hk6
    s_waitcnt vmcnt(0)
    v_xor_b32 v40, v40, v112
    v_xor_b32 v42, v42, v113
    v_xor_b32 v44, v44, v112
    v_xor_b32 v46, v46, v113
    v_or3_b32 v56, v40, v42, v44
    v_or_b32 v56, v56, v46
    v_and_b32 v56, 0x80008000, v56
    v_cmp_ne_u32 vcc, 0, v56
    s_cbranch_vccnz kf_kernel_hr6
    s_nop 0
    s_branch kf_kernel_hk6
kf_kernel_c6s:
    s_mov_b32 s35, 0
kf_kernel_c6:
    ds_read_b32 v60, v125
    s_add_u32 s35, s35, 1
    s_cmp_gt_u32 s35, 65536
    s_cbranch_scc1 kf_kernel_c6o
    s_waitcnt lgkmcnt(0)
    v_cmp_gt_u32 vcc, 3, v60
    s_cbranch_vccnz kf_kernel_c6
kf_kernel_c6o:
    s_branch kf_kernel_c6b
kf_kernel_hr7:
    s_sleep 2
    s_add_u32 s35, s45, 8192
    s_add_u32 s36, s46, 8192
    buffer_load_dwordx4 v[48:51], v9, s[64:67], s35 offen offset:3072 sc1
    buffer_load_dwordx4 v[52:55], v9, s[64:67], s36 offen offset:3072 sc1
    s_add_u32 s35, s45, 16384
    s_add_u32 s36, s46, 16384
    buffer_load_dwordx4 v[80:83], v9, s[64:67], s35 offen offset:0 sc1
    buffer_load_dwordx4 v[84:87], v9, s[64:67], s36 offen offset:0 sc1
    buffer_load_dwordx4 v[88:91], v9, s[64:67], s35 offen offset:1024 sc1
    buffer_load_dwordx4 v[92:95], v9, s[64:67], s36 offen offset:1024 sc1
    buffer_load_dwordx4 v[96:99], v9, s[64:67], s35 offen offset:2048 sc1
    buffer_load_dwordx4 v[100:103], v9, s[64:67], s36 offen offset:2048 sc1
    s_add_u32 s47, s47, 1
    s_cmp_gt_u32 s47, 65536
    s_cbranch_scc1 kf_kernel_hk7
    s_waitcnt vmcnt(0)
    v_xor_b32 v48, v48, v112
    v_xor_b32 v50, v50, v113
    v_xor_b32 v52, v52, v112
    v_xor_b32 v54, v54, v113
    v_or3_b32 v56, v48, v50, v52
    v_or_b32 v56, v56, v54
    v_and_b32 v56, 0x80008000, v56
    v_cmp_ne_u32 vcc, 0, v56
    s_cbranch_vccnz kf_kernel_hr7
    s_nop 0
    s_branch kf_kernel_hk7
kf_kernel_hr8:
    s_sleep 2
    s_add_u32 s35, s45, 16384
    s_add_u32 s36, s46, 16384
    buffer_load_dwordx4 v[80:83], v9, s[64:67], s35 offen offset:0 sc1
    buffer_load_dwordx4 v[84:87], v9, s[64:67], s36 offen offset:0 sc1
    buffer_load_dwordx4 v[88:91], v9, s[64:67], s35 offen offset:1024 sc1
    buffer_load_dwordx4 v[92:95], v9, s[64:67], s36 offen offset:1024 sc1
    buffer_load_dwordx4 v[96:99], v9, s[64:67], s35 offen offset:2048 sc1
    buffer_load_dwordx4 v[100:103], v9, s[64:67], s36 offen offset:2048 sc1
    buffer_load_dwordx4 v[104:107], v9, s[64:67], s35 offen offset:3072 sc1
    buffer_load_dwordx4 v[108:111], v9, s[64:67], s36 offen offset:3072 sc1
    s_add_u32 s47, s47, 1
    s_cmp_gt_u32 s47, 65536
    s_cbranch_scc1 kf_kernel_hk8
    s_waitcnt vmcnt(0)
    v_xor_b32 v80, v80, v112
    v_xor_b32 v82, v82, v113
    v_xor_b32 v84, v84, v112
    v_xor_b32 v86, v86, v113
    v_or3_b32 v56, v80, v82, v84
    v_or_b32 v56, v56, v86
    v_and_b32 v56, 0x80008000, v56
    v_cmp_ne_u32 vcc, 0, v56
    s_cbranch_vccnz kf_kernel_hr8
    s_nop 0
    s_branch kf_kernel_hk8
kf_kernel_hr9:
    s_sleep 2
    s_add_u32 s35, s45, 16384
    s_add_u32 s36, s46, 16384
    buffer_load_dwordx4 v[88:91], v9, s[64:67], s35 offen offset:1024 sc1
    buffer_load_dwordx4 v[92:95], v9, s[64:67], s36 offen offset:1024 sc1
    buffer_load_dwordx4 v[96:99], v9, s[64:67], s35 offen offset:2048 sc1
    buffer_load_dwordx4 v[100:103], v9, s[64:67], s36 offen offset:2048 sc1
    buffer_load_dwordx4 v[104:107], v9, s[64:67], s35 offen offset:3072 sc1
    buffer_load_dwordx4 v[108:111], v9, s[64:67], s36 offen offset:3072 sc1
    s_add_u32 s35, s58, 0
    s_add_u32 s36, s59, 0
    buffer_load_dwordx4 v[24:27], v9, s[64:67], s35 offen offset:0 sc1
    buffer_load_dwordx4 v[28:31], v9, s[64:67], s36 offen offset:0 sc1
    s_add_u32 s47, s47, 1
    s_cmp_gt_u32 s47, 65536
    s_cbranch_scc1 kf_kernel_hk9
    s_waitcnt vmcnt(0)
    v_xor_b32 v88, v88, v112
    v_xor_b32 v90, v90, v113
    v_xor_b32 v92, v92, v112
    v_xor_b32 v94, v94, v113
    v_or3_b32 v56, v88, v90, v92
    v_or_b32 v56, v56, v94
    v_and_b32 v56, 0x80008000, v56
    v_cmp_ne_u32 vcc, 0, v56
    s_cbranch_vccnz kf_kernel_hr9
    s_nop 0
    s_branch kf_kernel_hk9
kf_kernel_hr10:
    s_sleep 2
    s_add_u32 s35, s45, 16384
    s_add_u32 s36, s46, 16384
    buffer_load_dwordx4 v[96:99], v9, s[64:67], s35 offen offset:2048 sc1
    buffer_load_dwordx4 v[100:103], v9, s[64:67], s36 offen offset:2048 sc1
    buffer_load_dwordx4 v[104:107], v9, s[64:67], s35 offen offset:3072 sc1
    buffer_load_dwordx4 v[108:111], v9, s[64:67], s36 offen offset:3072 sc1
    s_add_u32 s35, s58, 0
    s_add_u32 s36, s59, 0
    buffer_load_dwordx4 v[24:27], v9, s[64:67], s35 offen offset:0 sc1
    buffer_load_dwordx4 v[28:31], v9, s[64:67], s36 offen offset:0 sc1
    buffer_load_dwordx4 v[32:35], v9, s[64:67], s35 offen offset:1024 sc1
    buffer_load_dwordx4 v[36:39], v9, s[64:67], s36 offen offset:1024 sc1
    s_add_u32 s47, s47, 1
    s_cmp_gt_u32 s47, 65536
    s_cbranch_scc1 kf_kernel_hk10
    s_waitcnt vmcnt(0)
    v_xor_b32 v96, v96, v112
    v_xor_b32 v98, v98, v113
    v_xor_b32 v100, v100, v112
    v_xor_b32 v102, v102, v113
    v_or3_b32 v56, v96, v98, v100
    v_or_b32 v56, v56, v102
    v_and_b32 v56, 0x80008000, v56
    v_cmp_ne_u32 vcc, 0, v56
    s_cbranch_vccnz kf_kernel_hr10
    s_nop 0
    s_branch kf_kernel_hk10
kf_kernel_c10s:
    s_mov_b32 s35, 0
kf_kernel_c10:
    ds_read_b32 v60, v125
    s_add_u32 s35, s35, 1
    s_cmp_gt_u32 s35, 65536
    s_cbranch_scc1 kf_kernel_c10o
    s_waitcnt lgkmcnt(0)
    v_cmp_gt_u32 vcc, 4, v60
    s_cbranch_vccnz kf_kernel_c10
kf_kernel_c10o:
    s_branch kf_kernel_c10b
kf_kernel_hr11:
    s_sleep 2
    s_add_u32 s35, s45, 16384
    s_add_u32 s36, s46, 16384
    buffer_load_dwordx4 v[104:107], v9, s[64:67], s35 offen offset:3072 sc1
    buffer_load_dwordx4 v[108:111], v9, s[64:67], s36 offen offset:3072 sc1
    s_add_u32 s35, s58, 0
    s_add_u32 s36, s59, 0
    buffer_load_dwordx4 v[24:27], v9, s[64:67], s35 offen offset:0 sc1
    buffer_load_dwordx4 v[28:31], v9, s[64:67], s36 offen offset:0 sc1
    buffer_load_dwordx4 v[32:35], v9, s[64:67], s35 offen offset:1024 sc1
    buffer_load_dwordx4 v[36:39], v9, s[64:67], s36 offen offset:1024 sc1
    s_add_u32 s35, s45, 4096
    s_add_u32 s36, s46, 4096
    buffer_load_dwordx4 v[40:43], v9, s[64:67], s35 offen offset:0 sc1
    buffer_load_dwordx4 v[44:47], v9, s[64:67], s36 offen offset:0 sc1
    s_add_u32 s47, s47, 1
    s_cmp_gt_u32 s47, 65536
    s_cbranch_scc1 kf_kernel_hk11
    s_waitcnt vmcnt(0)
    v_xor_b32 v104, v104, v112
    v_xor_b32 v106, v106, v113
    v_xor_b32 v108, v108, v112
    v_xor_b32 v110, v110, v113
    v_or3_b32 v56, v104, v106, v108
    v_or_b32 v56, v56, v110
    v_and_b32 v56, 0x80008000, v56
    v_cmp_ne_u32 vcc, 0, v56
    s_cbranch_vccnz kf_kernel_hr11
    s_nop 0
    s_branch kf_kernel_hk11
kf_kernel_hr12:
    s_sleep 2
    s_add_u32 s35, s58, 0
    s_add_u32 s36, s59, 0
    buffer_load_dwordx4 v[24:27], v9, s[64:67], s35 offen offset:0 sc1
    buffer_load_dwordx4 v[28:31], v9, s[64:67], s36 offen offset:0 sc1
    buffer_load_dwordx4 v[32:35], v9, s[64:67], s35 offen offset:1024 sc1
    buffer_load_dwordx4 v[36:39], v9, s[64:67], s36 offen offset:1024 sc1
    s_add_u32 s35, s45, 4096
    s_add_u32 s36, s46, 4096
    buffer_load_dwordx4 v[40:43], v9, s[64:67], s35 offen offset:0 sc1
    buffer_load_dwordx4 v[44:47], v9, s[64:67], s36 offen offset:0 sc1
    buffer_load_dwordx4 v[48:51], v9, s[64:67], s35 offen offset:1024 sc1
    buffer_load_dwordx4 v[52:55], v9, s[64:67], s36 offen offset:1024 sc1
    s_add_u32 s47, s47, 1
    s_cmp_gt_u32 s47, 65536
    s_cbranch_scc1 kf_kernel_hk12
    s_waitcnt vmcnt(0)
    v_xor_b32 v24, v24, v112
    v_xor_b32 v26, v26, v113
    v_xor_b32 v28, v28, v112
    v_xor_b32 v30, v30, v113
    v_or3_b32 v56, v24, v26, v28
    v_or_b32 v56, v56, v30
    v_and_b32 v56, 0x80008000, v56
    v_cmp_ne_u32 vcc, 0, v56
    s_cbranch_vccnz kf_kernel_hr12
    s_nop 0
    s_branch kf_kernel_hk12
kf_kernel_c12s:
    s_mov_b32 s35, 0
kf_kernel_c12:
    ds_read_b32 v60, v125
    s_add_u32 s35, s35, 1
    s_cmp_gt_u32 s35, 65536
    s_cbranch_scc1 kf_kernel_c12o
    s_waitcnt lgkmcnt(0)
    v_cmp_gt_u32 vcc, 5, v60
    s_cbranch_vccnz kf_kernel_c12
kf_kernel_c12o:
    s_branch kf_kernel_c12b
kf_kernel_hr13:
    s_sleep 2
    s_add_u32 s35, s58, 0
    s_add_u32 s36, s59, 0
    buffer_load_dwordx4 v[32:35], v9, s[64:67], s35 offen offset:1024 sc1
    buffer_load_dwordx4 v[36:39], v9, s[64:67], s36 offen offset:1024 sc1
    s_add_u32 s35, s45, 4096
    s_add_u32 s36, s46, 4096
    buffer_load_dwordx4 v[40:43], v9, s[64:67], s35 offen offset:0 sc1
    buffer_load_dwordx4 v[44:47], v9, s[64:67], s36 offen offset:0 sc1
    buffer_load_dwordx4 v[48:51], v9, s[64:67], s35 offen offset:1024 sc1
    buffer_load_dwordx4 v[52:55], v9, s[64:67], s36 offen offset:1024 sc1
    s_add_u32 s35, s45, 12288
    s_add_u32 s36, s46, 12288
    buffer_load_dwordx4 v[80:83], v9, s[64:67], s35 offen offset:0 sc1
    buffer_load_dwordx4 v[84:87], v9, s[64:67], s36 offen offset:0 sc1
    s_add_u32 s47, s47, 1
    s_cmp_gt_u32 s47, 65536
    s_cbranch_scc1 kf_kernel_hk13
    s_waitcnt vmcnt(0)
    v_xor_b32 v32, v32, v112
    v_xor_b32 v34, v34, v113
    v_xor_b32 v36, v36, v112
    v_xor_b32 v38, v38, v113
    v_or3_b32 v56, v32, v34, v36
    v_or_b32 v56, v56, v38
    v_and_b32 v56, 0x80008000, v56
    v_cmp_ne_u32 vcc, 0, v56
    s_cbranch_vccnz kf_kernel_hr13
    s_nop 0
    s_branch kf_kernel_hk13
kf_kernel_hr14:
    s_sleep 2
    s_add_u32 s35, s45, 4096
    s_add_u32 s36, s46, 4096
    buffer_load_dwordx4 v[40:43], v9, s[64:67], s35 offen offset:0 sc1
    buffer_load_dwordx4 v[44:47], v9, s[64:67], s36 offen offset:0 sc1
    buffer_load_dwordx4 v[48:51], v9, s[64:67], s35 offen offset:1024 sc1
    buffer_load_dwordx4 v[52:55], v9, s[64:67], s36 offen offset:1024 sc1
    s_add_u32 s35, s45, 12288
    s_add_u32 s36, s46, 12288
    buffer_load_dwordx4 v[80:83], v9, s[64:67], s35 offen offset:0 sc1
    buffer_load_dwordx4 v[84:87], v9, s[64:67], s36 offen offset:0 sc1
    buffer_load_dwordx4 v[88:91], v9, s[64:67], s35 offen offset:1024 sc1
    buffer_load_dwordx4 v[92:95], v9, s[64:67], s36 offen offset:1024 sc1
    s_add_u32 s47, s47, 1
    s_cmp_gt_u32 s47, 65536
    s_cbranch_scc1 kf_kernel_hk14
    s_waitcnt vmcnt(0)
    v_xor_b32 v40, v40, v112
    v_xor_b32 v42, v42, v113
    v_xor_b32 v44, v44, v112
    v_xor_b32 v46, v46, v113
    v_or3_b32 v56, v40, v42, v44
    v_or_b32 v56, v56, v46
    v_and_b32 v56, 0x80008000, v56
    v_cmp_ne_u32 vcc, 0, v56
    s_cbranch_vccnz kf_kernel_hr14
    s_nop 0
    s_branch kf_kernel_hk14
kf_kernel_c14s:
    s_mov_b32 s35, 0
kf_kernel_c14:
    ds_read_b32 v60, v125
    s_add_u32 s35, s35, 1
    s_cmp_gt_u32 s35, 65536
    s_cbranch_scc1 kf_kernel_c14o
    s_waitcnt lgkmcnt(0)
    v_cmp_gt_u32 vcc, 6, v60
    s_cbranch_vccnz kf_kernel_c14
kf_kernel_c14o:
    s_branch kf_kernel_c14b
kf_kernel_hr15:
    s_sleep 2
    s_add_u32 s35, s45, 4096
    s_add_u32 s36, s46, 4096
    buffer_load_dwordx4 v[48:51], v9, s[64:67], s35 offen offset:1024 sc1
    buffer_load_dwordx4 v[52:55], v9, s[64:67], s36 offen offset:1024 sc1
    s_add_u32 s35, s45, 12288
    s_add_u32 s36, s46, 12288
    buffer_load_dwordx4 v[80:83], v9, s[64:67], s35 offen offset:0 sc1
    buffer_load_dwordx4 v[84:87], v9, s[64:67], s36 offen offset:0 sc1
    buffer_load_dwordx4 v[88:91], v9, s[64:67], s35 offen offset:1024 sc1
    buffer_load_dwordx4 v[92:95], v9, s[64:67], s36 offen offset:1024 sc1
    s_add_u32 s35, s58, 0
    s_add_u32 s36, s59, 0
    buffer_load_dwordx4 v[96:99], v9, s[64:67], s35 offen offset:2048 sc1
    buffer_load_dwordx4 v[100:103], v9, s[64:67], s36 offen offset:2048 sc1
    s_add_u32 s47, s47, 1
    s_cmp_gt_u32 s47, 65536
    s_cbranch_scc1 kf_kernel_hk15
    s_waitcnt vmcnt(0)
    v_xor_b32 v48, v48, v112
    v_xor_b32 v50, v50, v113
    v_xor_b32 v52, v52, v112
    v_xor_b32 v54, v54, v113
    v_or3_b32 v56, v48, v50, v52
    v_or_b32 v56, v56, v54
    v_and_b32 v56, 0x80008000, v56
    v_cmp_ne_u32 vcc, 0, v56
    s_cbranch_vccnz kf_kernel_hr15
    s_nop 0
    s_branch kf_kernel_hk15
kf_kernel_hr16:
    s_sleep 2
    s_add_u32 s35, s45, 12288
    s_add_u32 s36, s46, 12288
    buffer_load_dwordx4 v[80:83], v9, s[64:67], s35 offen offset:0 sc1
    buffer_load_dwordx4 v[84:87], v9, s[64:67], s36 offen offset:0 sc1
    buffer_load_dwordx4 v[88:91], v9, s[64:67], s35 offen offset:1024 sc1
    buffer_load_dwordx4 v[92:95], v9, s[64:67], s36 offen offset:1024 sc1
    s_add_u32 s35, s58, 0
    s_add_u32 s36, s59, 0
    buffer_load_dwordx4 v[96:99], v9, s[64:67], s35 offen offset:2048 sc1
    buffer_load_dwordx4 v[100:103], v9, s[64:67], s36 offen offset:2048 sc1
    buffer_load_dwordx4 v[104:107], v9, s[64:67], s35 offen offset:3072 sc1
    buffer_load_dwordx4 v[108:111], v9, s[64:67], s36 offen offset:3072 sc1
    s_add_u32 s47, s47, 1
    s_cmp_gt_u32 s47, 65536
    s_cbranch_scc1 kf_kernel_hk16
    s_waitcnt vmcnt(0)
    v_xor_b32 v80, v80, v112
    v_xor_b32 v82, v82, v113
    v_xor_b32 v84, v84, v112
    v_xor_b32 v86, v86, v113
    v_or3_b32 v56, v80, v82, v84
    v_or_b32 v56, v56, v86
    v_and_b32 v56, 0x80008000, v56
    v_cmp_ne_u32 vcc, 0, v56
    s_cbranch_vccnz kf_kernel_hr16
    s_nop 0
    s_branch kf_kernel_hk16
kf_kernel_hr17:
    s_sleep 2
    s_add_u32 s35, s45, 12288
    s_add_u32 s36, s46, 12288
    buffer_load_dwordx4 v[88:91], v9, s[64:67], s35 offen offset:1024 sc1
    buffer_load_dwordx4 v[92:95], v9, s[64:67], s36 offen offset:1024 sc1
    s_add_u32 s35, s58, 0
    s_add_u32 s36, s59, 0
    buffer_load_dwordx4 v[96:99], v9, s[64:67], s35 offen offset:2048 sc1
    buffer_load_dwordx4 v[100:103], v9, s[64:67], s36 offen offset:2048 sc1
    buffer_load_dwordx4 v[104:107], v9, s[64:67], s35 offen offset:3072 sc1
    buffer_load_dwordx4 v[108:111], v9, s[64:67], s36 offen offset:3072 sc1
    s_add_u32 s47, s47, 1
    s_cmp_gt_u32 s47, 65536
    s_cbranch_scc1 kf_kernel_hk17
    s_waitcnt vmcnt(0)
    v_xor_b32 v88, v88, v112
    v_xor_b32 v90, v90, v113
    v_xor_b32 v92, v92, v112
    v_xor_b32 v94, v94, v113
    v_or3_b32 v56, v88, v90, v92
    v_or_b32 v56, v56, v94
    v_and_b32 v56, 0x80008000, v56
    v_cmp_ne_u32 vcc, 0, v56
    s_cbranch_vccnz kf_kernel_hr17
    s_nop 0
    s_branch kf_kernel_hk17
kf_kernel_hr18:
    s_sleep 2
    s_add_u32 s35, s58, 0
    s_add_u32 s36, s59, 0
    buffer_load_dwordx4 v[96:99], v9, s[64:67], s35 offen offset:2048 sc1
    buffer_load_dwordx4 v[100:103], v9, s[64:67], s36 offen offset:2048 sc1
    buffer_load_dwordx4 v[104:107], v9, s[64:67], s35 offen offset:3072 sc1
    buffer_load_dwordx4 v[108:111], v9, s[64:67], s36 offen offset:3072 sc1
    s_add_u32 s47, s47, 1
    s_cmp_gt_u32 s47, 65536
    s_cbranch_scc1 kf_kernel_hk18
    s_waitcnt vmcnt(0)
    v_xor_b32 v96, v96, v112
    v_xor_b32 v98, v98, v113
    v_xor_b32 v100, v100, v112
    v_xor_b32 v102, v102, v113
    v_or3_b32 v56, v96, v98, v100
    v_or_b32 v56, v56, v102
    v_and_b32 v56, 0x80008000, v56
    v_cmp_ne_u32 vcc, 0, v56
    s_cbranch_vccnz kf_kernel_hr18
    s_nop 0
    s_branch kf_kernel_hk18
kf_kernel_c18s:
    s_mov_b32 s35, 0
kf_kernel_c18:
    ds_read_b32 v60, v125
    s_add_u32 s35, s35, 1
    s_cmp_gt_u32 s35, 65536
    s_cbranch_scc1 kf_kernel_c18o
    s_waitcnt lgkmcnt(0)
    v_cmp_gt_u32 vcc, 7, v60
    s_cbranch_vccnz kf_kernel_c18
kf_kernel_c18o:
    s_branch kf_kernel_c18b
kf_kernel_hr19:
    s_sleep 2
    s_add_u32 s35, s58, 0
    s_add_u32 s36, s59, 0
    buffer_load_dwordx4 v[104:107], v9, s[64:67], s35 offen offset:3072 sc1
    buffer_load_dwordx4 v[108:111], v9, s[64:67], s36 offen offset:3072 sc1
    s_add_u32 s47, s47, 1
    s_cmp_gt_u32 s47, 65536
    s_cbranch_scc1 kf_kernel_hk19
    s_waitcnt vmcnt(0)
    v_xor_b32 v104, v104, v112
    v_xor_b32 v106, v106, v113
    v_xor_b32 v108, v108, v112
    v_xor_b32 v110, v110, v113
    v_or3_b32 v56, v104, v106, v108
    v_or_b32 v56, v56, v110
    v_and_b32 v56, 0x80008000, v56
    v_cmp_ne_u32 vcc, 0, v56
    s_cbranch_vccnz kf_kernel_hr19
    s_nop 0
    s_branch kf_kernel_hk19
kf_kernel_hr20x:
    s_sleep 2
    s_add_u32 s36, s46, 20480
    buffer_load_dwordx4 v[24:27], v9, s[64:67], s36 offen offset:0 sc1
    buffer_load_dwordx4 v[28:31], v9, s[64:67], s36 offen offset:1024 sc1
    s_add_u32 s36, s46, 4096
    buffer_load_dwordx4 v[32:35], v9, s[64:67], s36 offen offset:2048 sc1
    buffer_load_dwordx4 v[36:39], v9, s[64:67], s36 offen offset:3072 sc1
    s_add_u32 s47, s47, 1
    s_cmp_gt_u32 s47, 65536
    s_cbranch_scc1 kf_kernel_hk20x
    s_waitcnt vmcnt(0)
    v_xor_b32 v24, v24, v112
    v_xor_b32 v26, v26, v113
    v_xor_b32 v28, v28, v112
    v_xor_b32 v30, v30, v113
    v_or3_b32 v56, v24, v26, v28
    v_or_b32 v56, v56, v30
    v_and_b32 v56, 0x80008000, v56
    v_cmp_ne_u32 vcc, 0, v56
    s_cbranch_vccnz kf_kernel_hr20x
    s_nop 0
    s_branch kf_kernel_hk20x
kf_kernel_hr22x:
    s_sleep 2
    s_add_u32 s36, s46, 4096
    buffer_load_dwordx4 v[32:35], v9, s[64:67], s36 offen offset:2048 sc1
    buffer_load_dwordx4 v[36:39], v9, s[64:67], s36 offen offset:3072 sc1
    s_add_u32 s36, s46, 12288
    buffer_load_dwordx4 v[40:43], v9, s[64:67], s36 offen offset:2048 sc1
    buffer_load_dwordx4 v[44:47], v9, s[64:67], s36 offen offset:3072 sc1
    s_add_u32 s47, s47, 1
    s_cmp_gt_u32 s47, 65536
    s_cbranch_scc1 kf_kernel_hk22x
    s_waitcnt vmcnt(0)
    v_xor_b32 v32, v32, v112
    v_xor_b32 v34, v34, v113
    v_xor_b32 v36, v36, v112
    v_xor_b32 v38, v38, v113
    v_or3_b32 v56, v32, v34, v36
    v_or_b32 v56, v56, v38
    v_and_b32 v56, 0x80008000, v56
    v_cmp_ne_u32 vcc, 0, v56
    s_cbranch_vccnz kf_kernel_hr22x
    s_nop 0
    s_branch kf_kernel_hk22x
kf_kernel_hr24x:
    s_sleep 2
    s_add_u32 s36, s46, 12288
    buffer_load_dwordx4 v[40:43], v9, s[64:67], s36 offen offset:2048 sc1
    buffer_load_dwordx4 v[44:47], v9, s[64:67], s36 offen offset:3072 sc1
    s_add_u32 s36, s46, 20480
    buffer_load_dwordx4 v[48:51], v9, s[64:67], s36 offen offset:2048 sc1
    buffer_load_dwordx4 v[52:55], v9, s[64:67], s36 offen offset:3072 sc1
    s_add_u32 s47, s47, 1
    s_cmp_gt_u32 s47, 65536
    s_cbranch_scc1 kf_kernel_hk24x
    s_waitcnt vmcnt(0)
    v_xor_b32 v40, v40, v112
    v_xor_b32 v42, v42, v113
    v_xor_b32 v44, v44, v112
    v_xor_b32 v46, v46, v113
    v_or3_b32 v56, v40, v42, v44
    v_or_b32 v56, v56, v46
    v_and_b32 v56, 0x80008000, v56
    v_cmp_ne_u32 vcc, 0, v56
    s_cbranch_vccnz kf_kernel_hr24x
    s_nop 0
    s_branch kf_kernel_hk24x
kf_kernel_hr26x:
    s_sleep 2
    s_add_u32 s36, s46, 20480
    buffer_load_dwordx4 v[48:51], v9, s[64:67], s36 offen offset:2048 sc1
    buffer_load_dwordx4 v[52:55], v9, s[64:67], s36 offen offset:3072 sc1
    s_add_u32 s47, s47, 1
    s_cmp_gt_u32 s47, 65536
    s_cbranch_scc1 kf_kernel_hk26x
    s_waitcnt vmcnt(0)
    v_xor_b32 v48, v48, v112
    v_xor_b32 v50, v50, v113
    v_xor_b32 v52, v52, v112
    v_xor_b32 v54, v54, v113
    v_or3_b32 v56, v48, v50, v52
    v_or_b32 v56, v56, v54
    v_and_b32 v56, 0x80008000, v56
    v_cmp_ne_u32 vcc, 0, v56
    s_cbranch_vccnz kf_kernel_hr26x
    s_nop 0
    s_branch kf_kernel_hk26x
kf_kernel_cxs:
    s_mov_b32 s35, 0
kf_kernel_cx:
    ds_read_b128 v[60:63], v126 offset:48
    s_add_u32 s35, s35, 1
    s_cmp_gt_u32 s35, 65536
    s_cbranch_scc1 kf_kernel_cxo
    s_waitcnt lgkmcnt(0)
    v_min_u32 v60, v60, v61
    v_min3_u32 v60, v60, v62, v63
    v_cmp_gt_u32 vcc, 8, v60
    s_cbranch_vccnz kf_kernel_cx
kf_kernel_cxo:
    s_branch kf_kernel_cxb
kf_kernel_hr20y:
    s_sleep 2
    s_add_u32 s35, s45, 20480
    buffer_load_dwordx4 v[80:83], v9, s[64:67], s35 offen offset:0 sc1
    buffer_load_dwordx4 v[84:87], v9, s[64:67], s35 offen offset:1024 sc1
    s_add_u32 s35, s45, 4096
    buffer_load_dwordx4 v[88:91], v9, s[64:67], s35 offen offset:2048 sc1
    buffer_load_dwordx4 v[92:95], v9, s[64:67], s35 offen offset:3072 sc1
    s_add_u32 s47, s47, 1
    s_cmp_gt_u32 s47, 65536
    s_cbranch_scc1 kf_kernel_hk20y
    s_waitcnt vmcnt(0)
    v_xor_b32 v80, v80, v112
    v_xor_b32 v82, v82, v113
    v_xor_b32 v84, v84, v112
    v_xor_b32 v86, v86, v113
    v_or3_b32 v56, v80, v82, v84
    v_or_b32 v56, v56, v86
    v_and_b32 v56, 0x80008000, v56
    v_cmp_ne_u32 vcc, 0, v56
    s_cbranch_vccnz kf_kernel_hr20y
    s_nop 0
    s_branch kf_kernel_hk20y
kf_kernel_hr22y:
    s_sleep 2
    s_add_u32 s35, s45, 4096
    buffer_load_dwordx4 v[88:91], v9, s[64:67], s35 offen offset:2048 sc1
    buffer_load_dwordx4 v[92:95], v9, s[64:67], s35 offen offset:3072 sc1
    s_add_u32 s35, s45, 12288
    buffer_load_dwordx4 v[96:99], v9, s[64:67], s35 offen offset:2048 sc1
    buffer_load_dwordx4 v[100:103], v9, s[64:67], s35 offen offset:3072 sc1
    s_add_u32 s47, s47, 1
    s_cmp_gt_u32 s47, 65536
    s_cbranch_scc1 kf_kernel_hk22y
    s_waitcnt vmcnt(0)
    v_xor_b32 v88, v88, v112
    v_xor_b32 v90, v90, v113
    v_xor_b32 v92, v92, v112
    v_xor_b32 v94, v94, v113
    v_or3_b32 v56, v88, v90, v92
    v_or_b32 v56, v56, v94
    v_and_b32 v56, 0x80008000, v56
    v_cmp_ne_u32 vcc, 0, v56
    s_cbranch_vccnz kf_kernel_hr22y
    s_nop 0
    s_branch kf_kernel_hk22y
kf_kernel_hr24y:
    s_sleep 2
    s_add_u32 s35, s45, 12288
    buffer_load_dwordx4 v[96:99], v9, s[64:67], s35 offen offset:2048 sc1
    buffer_load_dwordx4 v[100:103], v9, s[64:67], s35 offen offset:3072 sc1
    s_add_u32 s35, s45, 20480
    buffer_load_dwordx4 v[104:107], v9, s[64:67], s35 offen offset:2048 sc1
    buffer_load_dwordx4 v[108:111], v9, s[64:67], s35 offen offset:3072 sc1
    s_add_u32 s47, s47, 1
    s_cmp_gt_u32 s47, 65536
    s_cbranch_scc1 kf_kernel_hk24y
    s_waitcnt vmcnt(0)
    v_xor_b32 v96, v96, v112
    v_xor_b32 v98, v98, v113
    v_xor_b32 v100, v100, v112
    v_xor_b32 v102, v102, v113
    v_or3_b32 v56, v96, v98, v100
    v_or_b32 v56, v56, v102
    v_and_b32 v56, 0x80008000, v56
    v_cmp_ne_u32 vcc, 0, v56
    s_cbranch_vccnz kf_kernel_hr24y
    s_nop 0
    s_branch kf_kernel_hk24y
kf_kernel_hr26y:
    s_sleep 2
    s_add_u32 s35, s45, 20480
    buffer_load_dwordx4 v[104:107], v9, s[64:67], s35 offen offset:2048 sc1
    buffer_load_dwordx4 v[108:111], v9, s[64:67], s35 offen offset:3072 sc1
    s_add_u32 s47, s47, 1
    s_cmp_gt_u32 s47, 65536
    s_cbranch_scc1 kf_kernel_hk26y
    s_waitcnt vmcnt(0)
    v_xor_b32 v104, v104, v112
    v_xor_b32 v106, v106, v113
    v_xor_b32 v108, v108, v112
    v_xor_b32 v110, v110, v113
    v_or3_b32 v56, v104, v106, v108
    v_or_b32 v56, v56, v110
    v_and_b32 v56, 0x80008000, v56
    v_cmp_ne_u32 vcc, 0, v56
    s_cbranch_vccnz kf_kernel_hr26y
    s_nop 0
    s_branch kf_kernel_hk26y
kf_kernel_yw1:
    s_mov_b32 s54, 0
kf_kernel_yv1:
    ds_read_b128 v[84:87], v201 offset:16
    ds_read_b32 v88, v3
    s_add_u32 s54, s54, 1
    s_cmp_gt_u32 s54, 65536
    s_cbranch_scc1 kf_kernel_yu1
    s_waitcnt lgkmcnt(0)
    v_lshrrev_b32 v88, 1, v88
    v_and_b32 v84, v84, v85
    v_and_b32 v86, v86, v87
    v_and_b32 v84, v84, v86
    v_and_b32 v84, v84, v88
    v_cmp_ne_u32 vcc, 2, v84
    s_cbranch_vccnz kf_kernel_yv1
kf_kernel_yu1:
    ds_read_b128 v[64:67], v196 offset:0
    ds_read_b128 v[68:71], v196 offset:1088
    ds_read_b128 v[72:75], v196 offset:2176
    ds_read_b128 v[76:79], v196 offset:3264
    ds_read_b128 v[96:99], v194 offset:0
    ds_read_b128 v[100:103], v194 offset:1024
    ds_read_b128 v[104:107], v194 offset:2048
    ds_read_b128 v[108:111], v194 offset:3072
    s_branch kf_kernel_yk1
kf_kernel_yw0:
    s_mov_b32 s54, 0
kf_kernel_yv0:
    ds_read_b128 v[84:87], v201 offset:16
    ds_read_b32 v88, v3
    s_add_u32 s54, s54, 1
    s_cmp_gt_u32 s54, 65536
    s_cbranch_scc1 kf_kernel_yu0
    s_waitcnt lgkmcnt(0)
    v_lshrrev_b32 v88, 1, v88
    v_and_b32 v84, v84, v85
    v_and_b32 v86, v86, v87
    v_and_b32 v84, v84, v86
    v_and_b32 v84, v84, v88
    v_cmp_ne_u32 vcc, 2, v84
    s_cbranch_vccnz kf_kernel_yv0
kf_kernel_yu0:
    ds_read_b128 v[64:67], v196 offset:0
    ds_read_b128 v[68:71], v196 offset:1088
    ds_read_b128 v[72:75], v196 offset:2176
    ds_read_b128 v[76:79], v196 offset:3264
    ds_read_b128 v[96:99], v194 offset:0
    ds_read_b128 v[100:103], v194 offset:1024
    ds_read_b128 v[104:107], v194 offset:2048
    ds_read_b128 v[108:111], v194 offset:3072
    s_branch kf_kernel_yk0
kf_kernel_end:
    s_endpgm
code_end:
.section .rodata,"a"
.p2align 6
.amdhsa_kernel kf_kernel
  .amdhsa_next_free_vgpr 256
  .amdhsa_next_free_sgpr 102
  .amdhsa_accum_offset 256
  .amdhsa_group_segment_fixed_size 0
  .amdhsa_kernarg_size 104
  .amdhsa_user_sgpr_count 2
  .amdhsa_user_sgpr_kernarg_segment_ptr 1
  .amdhsa_system_sgpr_workgroup_id_x 1
  .amdhsa_float_denorm_mode_32 3
.end_amdhsa_kernel
```
